```python
import torch

def _softmax(x, axis=-1):
    return torch.softmax(x, dim=axis)
def _gelu(x):
    return torch.nn.functional.gelu(x, approximate="tanh")
def _silu(x):
    return torch.nn.functional.silu(x)
def _sigmoid(x):
    return torch.sigmoid(x)
def _layernorm(x, axis=-1, eps=1e-5):
    m = x.mean(dim=axis, keepdim=True)
    v = x.var(dim=axis, keepdim=True, unbiased=False)
    return (x - m) / torch.sqrt(v + eps)
def _scatter_add(tgt, idx, src, axis=0):
    return tgt.clone().index_add_(axis, idx, src)
def _segment_sum(src, seg, n):
    out = torch.zeros((n,) + src.shape[1:], dtype=src.dtype)
    return out.index_add_(0, seg, src)
def _pad(x, pw):
    flat = tuple(v for pair in reversed(pw) for v in pair)
    return torch.nn.functional.pad(x, flat)

kernel_name = 'gated_mix__grouped_kv_mqa__dense_activation_relu__prompt'

def setup_inputs():

    _w = (lambda a: (lambda t: t.to(torch.bfloat16) if t.is_floating_point() else t)(torch.as_tensor(a)))
    def _A_setup():
        B, S, D, H = 1, 2048, 512, 32
        Dh = D // H
        return {
            "x": _w((lambda *s: torch.randn(*s, dtype=torch.bfloat16) * 0.05)(B, S, D)),
            "wq": _w((lambda *s: torch.randn(*s, dtype=torch.bfloat16) * 0.8)(D, H * Dh)),
            "wk": _w((lambda *s: torch.randn(*s, dtype=torch.bfloat16) * 0.8)(D, Dh)),
            "wv": _w((lambda *s: torch.randn(*s, dtype=torch.bfloat16) * 0.2)(D, Dh)),
            "wo": _w((lambda *s: torch.randn(*s, dtype=torch.bfloat16) * 0.2)(H * Dh, D)),
        }
    _A_in = _A_setup()

    def _B_setup():
        B, S, D, Dff = 1, 2048, 512, 1792
        return {
            "x": _w((lambda *s: torch.randn(*s, dtype=torch.bfloat16) * 0.05)(B, S, D)),
            "w1": _w((lambda *s: torch.randn(*s, dtype=torch.bfloat16) * 0.05)(D, Dff)),
            "w2": _w((lambda *s: torch.randn(*s, dtype=torch.bfloat16) * 0.05)(Dff, D)),
        }
    _B_in = _B_setup()

    return {
        "A_x": _A_in["x"],
        "A_wq": _A_in["wq"],
        "A_wk": _A_in["wk"],
        "A_wv": _A_in["wv"],
        "A_wo": _A_in["wo"],
        "B_x": _B_in["x"],
        "B_w1": _B_in["w1"],
        "B_w2": _B_in["w2"],
        "gate_w": _w((lambda *s: torch.randn(*s, dtype=torch.bfloat16) * 0.05)(512) * 16.0),
    }

def reference(A_x, A_wq, A_wk, A_wv, A_wo, B_x, B_w1, B_w2, gate_w):
    def _A_ref(x, wq, wk, wv, wo):
        B, S, D = x.shape
        H = 32
        Dh = D // H
        q = (lambda x, *d: x.permute(*d))((x @ wq).reshape(B, S, H, Dh), 0, 2, 1, 3)
        k = x @ wk
        v = x @ wv
        scores = torch.einsum("bhqd,bkd->bhqk", q, k) * (Dh ** -0.5)
        p = _softmax(scores, axis=-1)
        o = torch.einsum("bhqk,bkd->bhqd", p, v)
        return (lambda x, *d: x.permute(*d))(o, 0, 2, 1, 3).reshape(B, S, H * Dh) @ wo

    def _B_ref(x, w1, w2):
        h = torch.einsum("bsd,df->bsf", x, w1)
        zero = torch.zeros_like(h)
        h = torch.maximum(h, zero)
        return torch.einsum("bsf,fd->bsd", h, w2)

    x = A_x
    g = _sigmoid((x * gate_w).sum(-1, keepdims=True))
    a = _A_ref(x, A_wq, A_wk, A_wv, A_wo)
    b = _B_ref(x, B_w1, B_w2)
    return g * a + (1 - g) * b
```

```asm
; @launch grid=(256,1,1) block=(512,1,1) lds=162304
.amdgcn_target "amdgcn-amd-amdhsa--gfx950"
.text
.globl gated_mix__grouped_kv_mqa__dense_activation_relu__prompt_kernel
.p2align 8
.type gated_mix__grouped_kv_mqa__dense_activation_relu__prompt_kernel,@function
gated_mix__grouped_kv_mqa__dense_activation_relu__prompt_kernel:

    s_cmp_ge_u32 s2, 256
    s_cbranch_scc1 F_end
    s_load_dwordx16 s[8:23], s[0:1], 0
    s_load_dwordx8 s[24:31], s[0:1], 64
    v_lshrrev_b32 v1, 6, v0
    s_bfe_u32 s4, s2, 0x20001
    s_lshl_b32 s4, s4, 3
    s_bfe_u32 s5, s2, 0x30003
    s_add_u32 s4, s4, s5
    v_readfirstlane_b32 s3, v1
    s_and_b32 s5, s2, 1
    s_lshl_b32 s5, s5, 2
    s_add_u32 s5, s5, 3
    s_lshr_b32 s6, s2, 6
    s_sub_u32 s5, s5, s6
    v_and_b32 v1, 63, v0
    s_mov_b32 s58, 0
    v_lshlrev_b32 v2, 4, v1
    s_and_b32 s6, s3, 1
    s_lshl_b32 s6, s6, 7
    s_add_u32 s7, s6, 0
    v_xor_b32 v8, s7, v2
    s_add_u32 s7, s6, 16
    v_xor_b32 v9, s7, v2
    s_add_u32 s7, s6, 32
    v_xor_b32 v10, s7, v2
    s_add_u32 s7, s6, 48
    v_xor_b32 v11, s7, v2
    s_add_u32 s7, s6, 64
    v_xor_b32 v12, s7, v2
    s_add_u32 s7, s6, 80
    v_xor_b32 v13, s7, v2
    s_add_u32 s7, s6, 96
    v_xor_b32 v14, s7, v2
    s_add_u32 s7, s6, 112
    v_xor_b32 v15, s7, v2
    s_lshl_b32 s50, s4, 16
    s_lshl_b32 s51, s3, 13
    s_add_u32 s50, s50, s51
    v_lshlrev_b32 v4, 2, v1
    v_add_u32 v4, 162048, v4
    v_mov_b32 v5, 0
    ds_write_b32 v4, v5
    s_waitcnt lgkmcnt(0)
    s_mov_b32 s32, s8
    s_mov_b32 s33, s9
    s_mov_b32 s34, 0x200000
    s_mov_b32 s35, 0x00020000
    s_mov_b32 s44, s30
    s_mov_b32 s45, s31
    s_mov_b32 s46, 0x10000000
    s_mov_b32 s47, 0x00020000
    s_mov_b32 s48, s28
    s_mov_b32 s49, s29
    s_lshl_b32 s52, s2, 3
    s_add_u32 s52, s52, s3
    s_cmp_lg_u32 s52, 263
    s_cbranch_scc1 F_x
    v_mul_u32_u24 v4, 256, v1
    v_add_u32 v4, 2269184, v4
    s_mov_b32 exec_lo, 0xffffffff
    s_mov_b32 exec_hi, 0
    global_store_dword v4, v5, s[30:31] sc1
    s_mov_b64 exec, -1
F_x:
    s_cmp_eq_u32 s5, 7
    s_cbranch_scc1 F_j7
    s_cmp_ge_u32 s3, 4
    s_cbranch_scc1 F_gx
    s_mov_b32 s6, s3
    s_mov_b32 s36, s10
    s_mov_b32 s37, s11
    s_mov_b32 s38, 0x80000
    s_mov_b32 s39, 0x00020000
    v_lshrrev_b32 v4, 3, v1
    v_mul_u32_u24 v4, 1024, v4
    v_and_b32 v5, 7, v1
    v_bfe_u32 v3, v1, 4, 1
    v_lshlrev_b32 v3, 2, v3
    v_xor_b32 v5, v5, v3
    v_lshl_add_u32 v3, v5, 4, v4
    s_mov_b32 s40, s24
    s_mov_b32 s41, s25
    s_mov_b32 s42, 0x400
    s_mov_b32 s43, 0x00020000
    s_mov_b32 m0, 161024
    s_nop 0
    buffer_load_dwordx4 v2, s[40:43], 0 offen lds
    s_add_u32 s52, s51, 0
    s_add_u32 s53, s50, 0
    s_mov_b32 m0, s52
    s_nop 0
    buffer_load_dwordx4 v8, s[32:35], s53 offen lds
    s_add_u32 s52, s51, 1024
    s_add_u32 s53, s50, 1024
    s_mov_b32 m0, s52
    s_nop 0
    buffer_load_dwordx4 v9, s[32:35], s53 offen lds
    s_add_u32 s52, s51, 2048
    s_add_u32 s53, s50, 2048
    s_mov_b32 m0, s52
    s_nop 0
    buffer_load_dwordx4 v10, s[32:35], s53 offen lds
    s_add_u32 s52, s51, 3072
    s_add_u32 s53, s50, 3072
    s_mov_b32 m0, s52
    s_nop 0
    buffer_load_dwordx4 v11, s[32:35], s53 offen lds
    s_add_u32 s52, s51, 4096
    s_add_u32 s53, s50, 4096
    s_mov_b32 m0, s52
    s_nop 0
    buffer_load_dwordx4 v12, s[32:35], s53 offen lds
    s_add_u32 s52, s51, 5120
    s_add_u32 s53, s50, 5120
    s_mov_b32 m0, s52
    s_nop 0
    buffer_load_dwordx4 v13, s[32:35], s53 offen lds
    s_add_u32 s52, s51, 6144
    s_add_u32 s53, s50, 6144
    s_mov_b32 m0, s52
    s_nop 0
    buffer_load_dwordx4 v14, s[32:35], s53 offen lds
    s_add_u32 s52, s51, 7168
    s_add_u32 s53, s50, 7168
    s_mov_b32 m0, s52
    s_nop 0
    buffer_load_dwordx4 v15, s[32:35], s53 offen lds
    s_branch A_early
F_gx:
    s_add_u32 s52, s51, 0
    s_add_u32 s53, s50, 0
    s_mov_b32 m0, s52
    s_nop 0
    buffer_load_dwordx4 v8, s[32:35], s53 offen lds
    s_add_u32 s52, s51, 1024
    s_add_u32 s53, s50, 1024
    s_mov_b32 m0, s52
    s_nop 0
    buffer_load_dwordx4 v9, s[32:35], s53 offen lds
    s_add_u32 s52, s51, 2048
    s_add_u32 s53, s50, 2048
    s_mov_b32 m0, s52
    s_nop 0
    buffer_load_dwordx4 v10, s[32:35], s53 offen lds
    s_add_u32 s52, s51, 3072
    s_add_u32 s53, s50, 3072
    s_mov_b32 m0, s52
    s_nop 0
    buffer_load_dwordx4 v11, s[32:35], s53 offen lds
    s_add_u32 s52, s51, 4096
    s_add_u32 s53, s50, 4096
    s_mov_b32 m0, s52
    s_nop 0
    buffer_load_dwordx4 v12, s[32:35], s53 offen lds
    s_add_u32 s52, s51, 5120
    s_add_u32 s53, s50, 5120
    s_mov_b32 m0, s52
    s_nop 0
    buffer_load_dwordx4 v13, s[32:35], s53 offen lds
    s_add_u32 s52, s51, 6144
    s_add_u32 s53, s50, 6144
    s_mov_b32 m0, s52
    s_nop 0
    buffer_load_dwordx4 v14, s[32:35], s53 offen lds
    s_add_u32 s52, s51, 7168
    s_add_u32 s53, s50, 7168
    s_mov_b32 m0, s52
    s_nop 0
    buffer_load_dwordx4 v15, s[32:35], s53 offen lds
    s_branch G_start
F_j7:
    s_bitcmp1_b32 s3, 1
    s_cbranch_scc1 F_j7b
    s_cmp_lt_u32 s3, 4
    s_cselect_b32 s52, s12, s14
    s_cselect_b32 s53, s13, s15
    s_mov_b32 s36, s52
    s_mov_b32 s37, s53
    s_mov_b32 s38, 0x4000
    s_mov_b32 s39, 0x00020000
    s_and_b32 s54, s3, 3
    s_lshl_b32 s54, s54, 12
    s_cmp_lt_u32 s3, 4
    s_mov_b32 s55, 131072
    s_cselect_b32 s55, 65536, s55
    s_add_u32 s55, s55, s54
    s_add_u32 s52, s55, 0
    s_add_u32 s53, s54, 0
    s_mov_b32 m0, s52
    s_nop 0
    buffer_load_dwordx4 v2, s[36:39], s53 offen lds
    s_add_u32 s52, s55, 1024
    s_add_u32 s53, s54, 1024
    s_mov_b32 m0, s52
    s_nop 0
    buffer_load_dwordx4 v2, s[36:39], s53 offen lds
    s_add_u32 s52, s55, 2048
    s_add_u32 s53, s54, 2048
    s_mov_b32 m0, s52
    s_nop 0
    buffer_load_dwordx4 v2, s[36:39], s53 offen lds
    s_add_u32 s52, s55, 3072
    s_add_u32 s53, s54, 3072
    s_mov_b32 m0, s52
    s_nop 0
    buffer_load_dwordx4 v2, s[36:39], s53 offen lds
    s_add_u32 s52, s51, 0
    s_add_u32 s53, s50, 0
    s_mov_b32 m0, s52
    s_nop 0
    buffer_load_dwordx4 v8, s[32:35], s53 offen lds
    s_add_u32 s52, s51, 1024
    s_add_u32 s53, s50, 1024
    s_mov_b32 m0, s52
    s_nop 0
    buffer_load_dwordx4 v9, s[32:35], s53 offen lds
    s_add_u32 s52, s51, 2048
    s_add_u32 s53, s50, 2048
    s_mov_b32 m0, s52
    s_nop 0
    buffer_load_dwordx4 v10, s[32:35], s53 offen lds
    s_add_u32 s52, s51, 3072
    s_add_u32 s53, s50, 3072
    s_mov_b32 m0, s52
    s_nop 0
    buffer_load_dwordx4 v11, s[32:35], s53 offen lds
    s_add_u32 s52, s51, 4096
    s_add_u32 s53, s50, 4096
    s_mov_b32 m0, s52
    s_nop 0
    buffer_load_dwordx4 v12, s[32:35], s53 offen lds
    s_add_u32 s52, s51, 5120
    s_add_u32 s53, s50, 5120
    s_mov_b32 m0, s52
    s_nop 0
    buffer_load_dwordx4 v13, s[32:35], s53 offen lds
    s_add_u32 s52, s51, 6144
    s_add_u32 s53, s50, 6144
    s_mov_b32 m0, s52
    s_nop 0
    buffer_load_dwordx4 v14, s[32:35], s53 offen lds
    s_add_u32 s52, s51, 7168
    s_add_u32 s53, s50, 7168
    s_mov_b32 m0, s52
    s_nop 0
    buffer_load_dwordx4 v15, s[32:35], s53 offen lds
    s_branch F_j7c
F_j7b:
    s_add_u32 s52, s51, 0
    s_add_u32 s53, s50, 0
    s_mov_b32 m0, s52
    s_nop 0
    buffer_load_dwordx4 v8, s[32:35], s53 offen lds
    s_add_u32 s52, s51, 1024
    s_add_u32 s53, s50, 1024
    s_mov_b32 m0, s52
    s_nop 0
    buffer_load_dwordx4 v9, s[32:35], s53 offen lds
    s_add_u32 s52, s51, 2048
    s_add_u32 s53, s50, 2048
    s_mov_b32 m0, s52
    s_nop 0
    buffer_load_dwordx4 v10, s[32:35], s53 offen lds
    s_add_u32 s52, s51, 3072
    s_add_u32 s53, s50, 3072
    s_mov_b32 m0, s52
    s_nop 0
    buffer_load_dwordx4 v11, s[32:35], s53 offen lds
    s_add_u32 s52, s51, 4096
    s_add_u32 s53, s50, 4096
    s_mov_b32 m0, s52
    s_nop 0
    buffer_load_dwordx4 v12, s[32:35], s53 offen lds
    s_add_u32 s52, s51, 5120
    s_add_u32 s53, s50, 5120
    s_mov_b32 m0, s52
    s_nop 0
    buffer_load_dwordx4 v13, s[32:35], s53 offen lds
    s_add_u32 s52, s51, 6144
    s_add_u32 s53, s50, 6144
    s_mov_b32 m0, s52
    s_nop 0
    buffer_load_dwordx4 v14, s[32:35], s53 offen lds
    s_add_u32 s52, s51, 7168
    s_add_u32 s53, s50, 7168
    s_mov_b32 m0, s52
    s_nop 0
    buffer_load_dwordx4 v15, s[32:35], s53 offen lds
    s_cmp_lt_u32 s3, 4
    s_cselect_b32 s52, s12, s14
    s_cselect_b32 s53, s13, s15
    s_mov_b32 s36, s52
    s_mov_b32 s37, s53
    s_mov_b32 s38, 0x4000
    s_mov_b32 s39, 0x00020000
    s_and_b32 s54, s3, 3
    s_lshl_b32 s54, s54, 12
    s_cmp_lt_u32 s3, 4
    s_mov_b32 s55, 131072
    s_cselect_b32 s55, 65536, s55
    s_add_u32 s55, s55, s54
    s_add_u32 s52, s55, 0
    s_add_u32 s53, s54, 0
    s_mov_b32 m0, s52
    s_nop 0
    buffer_load_dwordx4 v2, s[36:39], s53 offen lds
    s_add_u32 s52, s55, 1024
    s_add_u32 s53, s54, 1024
    s_mov_b32 m0, s52
    s_nop 0
    buffer_load_dwordx4 v2, s[36:39], s53 offen lds
    s_add_u32 s52, s55, 2048
    s_add_u32 s53, s54, 2048
    s_mov_b32 m0, s52
    s_nop 0
    buffer_load_dwordx4 v2, s[36:39], s53 offen lds
    s_add_u32 s52, s55, 3072
    s_add_u32 s53, s54, 3072
    s_mov_b32 m0, s52
    s_nop 0
    buffer_load_dwordx4 v2, s[36:39], s53 offen lds
F_j7c:
    s_cmp_ge_u32 s3, 4
    s_cbranch_scc1 G_start
    s_mov_b32 s40, s24
    s_mov_b32 s41, s25
    s_mov_b32 s42, 0x400
    s_mov_b32 s43, 0x00020000
    s_mov_b32 m0, 161024
    s_nop 0
    buffer_load_dwordx4 v2, s[40:43], 0 offen lds
    s_branch A_j7
A_early:
    s_waitcnt vmcnt(0)
    s_barrier
    s_lshl_b32 s54, s6, 17
    s_lshl_b32 s55, s5, 7
    s_add_u32 s54, s54, s55
    s_lshl_b32 s55, s6, 14
    s_add_u32 s55, s55, 81920
    s_add_u32 s52, s55, 0
    s_add_u32 s53, s54, 0
    s_mov_b32 m0, s52
    s_nop 0
    buffer_load_dwordx4 v3, s[36:39], s53 offen lds
    s_add_u32 s52, s55, 1024
    s_add_u32 s53, s54, 8192
    s_mov_b32 m0, s52
    s_nop 0
    buffer_load_dwordx4 v3, s[36:39], s53 offen lds
    s_add_u32 s52, s55, 2048
    s_add_u32 s53, s54, 16384
    s_mov_b32 m0, s52
    s_nop 0
    buffer_load_dwordx4 v3, s[36:39], s53 offen lds
    s_add_u32 s52, s55, 3072
    s_add_u32 s53, s54, 24576
    s_mov_b32 m0, s52
    s_nop 0
    buffer_load_dwordx4 v3, s[36:39], s53 offen lds
    s_add_u32 s52, s55, 4096
    s_add_u32 s53, s54, 32768
    s_mov_b32 m0, s52
    s_nop 0
    buffer_load_dwordx4 v3, s[36:39], s53 offen lds
    s_add_u32 s52, s55, 5120
    s_add_u32 s53, s54, 40960
    s_mov_b32 m0, s52
    s_nop 0
    buffer_load_dwordx4 v3, s[36:39], s53 offen lds
    s_add_u32 s52, s55, 6144
    s_add_u32 s53, s54, 49152
    s_mov_b32 m0, s52
    s_nop 0
    buffer_load_dwordx4 v3, s[36:39], s53 offen lds
    s_add_u32 s52, s55, 7168
    s_add_u32 s53, s54, 57344
    s_mov_b32 m0, s52
    s_nop 0
    buffer_load_dwordx4 v3, s[36:39], s53 offen lds
    s_add_u32 s52, s55, 8192
    s_add_u32 s53, s54, 65536
    s_mov_b32 m0, s52
    s_nop 0
    buffer_load_dwordx4 v3, s[36:39], s53 offen lds
    s_add_u32 s52, s55, 9216
    s_add_u32 s53, s54, 73728
    s_mov_b32 m0, s52
    s_nop 0
    buffer_load_dwordx4 v3, s[36:39], s53 offen lds
    s_add_u32 s52, s55, 10240
    s_add_u32 s53, s54, 81920
    s_mov_b32 m0, s52
    s_nop 0
    buffer_load_dwordx4 v3, s[36:39], s53 offen lds
    s_add_u32 s52, s55, 11264
    s_add_u32 s53, s54, 90112
    s_mov_b32 m0, s52
    s_nop 0
    buffer_load_dwordx4 v3, s[36:39], s53 offen lds
    s_add_u32 s52, s55, 12288
    s_add_u32 s53, s54, 98304
    s_mov_b32 m0, s52
    s_nop 0
    buffer_load_dwordx4 v3, s[36:39], s53 offen lds
    s_add_u32 s52, s55, 13312
    s_add_u32 s53, s54, 106496
    s_mov_b32 m0, s52
    s_nop 0
    buffer_load_dwordx4 v3, s[36:39], s53 offen lds
    s_add_u32 s52, s55, 14336
    s_add_u32 s53, s54, 114688
    s_mov_b32 m0, s52
    s_nop 0
    buffer_load_dwordx4 v3, s[36:39], s53 offen lds
    s_add_u32 s52, s55, 15360
    s_add_u32 s53, s54, 122880
    s_mov_b32 m0, s52
    s_nop 0
    buffer_load_dwordx4 v3, s[36:39], s53 offen lds
    s_branch A_join
A_j7:
    s_mov_b32 s6, s3
    s_mov_b32 s36, s10
    s_mov_b32 s37, s11
    s_mov_b32 s38, 0x80000
    s_mov_b32 s39, 0x00020000
    v_lshrrev_b32 v4, 3, v1
    v_mul_u32_u24 v4, 1024, v4
    v_and_b32 v5, 7, v1
    v_bfe_u32 v3, v1, 4, 1
    v_lshlrev_b32 v3, 2, v3
    v_xor_b32 v5, v5, v3
    v_lshl_add_u32 v3, v5, 4, v4
    s_waitcnt vmcnt(0)
    s_barrier
    s_cmp_lg_u32 s6, 3
    s_cbranch_scc1 A_j7w
    v_mov_b32 v14, 162064
lw_1:
    ds_read_b32 v15, v14
    s_waitcnt lgkmcnt(0)
    v_readfirstlane_b32 s52, v15
    s_cmp_ge_u32 s52, 4
    s_cbranch_scc1 lw_1_d
    s_sleep 1
    s_add_u32 s58, s58, 1
    s_cmp_lt_u32 s58, 200000
    s_cbranch_scc1 lw_1
lw_1_d:
A_j7w:
    s_lshl_b32 s54, s6, 17
    s_lshl_b32 s55, s5, 7
    s_add_u32 s54, s54, s55
    s_lshl_b32 s55, s6, 14
    s_add_u32 s55, s55, 81920
    s_add_u32 s52, s55, 0
    s_add_u32 s53, s54, 0
    s_mov_b32 m0, s52
    s_nop 0
    buffer_load_dwordx4 v3, s[36:39], s53 offen lds
    s_add_u32 s52, s55, 1024
    s_add_u32 s53, s54, 8192
    s_mov_b32 m0, s52
    s_nop 0
    buffer_load_dwordx4 v3, s[36:39], s53 offen lds
    s_add_u32 s52, s55, 2048
    s_add_u32 s53, s54, 16384
    s_mov_b32 m0, s52
    s_nop 0
    buffer_load_dwordx4 v3, s[36:39], s53 offen lds
    s_add_u32 s52, s55, 3072
    s_add_u32 s53, s54, 24576
    s_mov_b32 m0, s52
    s_nop 0
    buffer_load_dwordx4 v3, s[36:39], s53 offen lds
    s_add_u32 s52, s55, 4096
    s_add_u32 s53, s54, 32768
    s_mov_b32 m0, s52
    s_nop 0
    buffer_load_dwordx4 v3, s[36:39], s53 offen lds
    s_add_u32 s52, s55, 5120
    s_add_u32 s53, s54, 40960
    s_mov_b32 m0, s52
    s_nop 0
    buffer_load_dwordx4 v3, s[36:39], s53 offen lds
    s_add_u32 s52, s55, 6144
    s_add_u32 s53, s54, 49152
    s_mov_b32 m0, s52
    s_nop 0
    buffer_load_dwordx4 v3, s[36:39], s53 offen lds
    s_add_u32 s52, s55, 7168
    s_add_u32 s53, s54, 57344
    s_mov_b32 m0, s52
    s_nop 0
    buffer_load_dwordx4 v3, s[36:39], s53 offen lds
    s_add_u32 s52, s55, 8192
    s_add_u32 s53, s54, 65536
    s_mov_b32 m0, s52
    s_nop 0
    buffer_load_dwordx4 v3, s[36:39], s53 offen lds
    s_add_u32 s52, s55, 9216
    s_add_u32 s53, s54, 73728
    s_mov_b32 m0, s52
    s_nop 0
    buffer_load_dwordx4 v3, s[36:39], s53 offen lds
    s_add_u32 s52, s55, 10240
    s_add_u32 s53, s54, 81920
    s_mov_b32 m0, s52
    s_nop 0
    buffer_load_dwordx4 v3, s[36:39], s53 offen lds
    s_add_u32 s52, s55, 11264
    s_add_u32 s53, s54, 90112
    s_mov_b32 m0, s52
    s_nop 0
    buffer_load_dwordx4 v3, s[36:39], s53 offen lds
    s_add_u32 s52, s55, 12288
    s_add_u32 s53, s54, 98304
    s_mov_b32 m0, s52
    s_nop 0
    buffer_load_dwordx4 v3, s[36:39], s53 offen lds
    s_add_u32 s52, s55, 13312
    s_add_u32 s53, s54, 106496
    s_mov_b32 m0, s52
    s_nop 0
    buffer_load_dwordx4 v3, s[36:39], s53 offen lds
    s_add_u32 s52, s55, 14336
    s_add_u32 s53, s54, 114688
    s_mov_b32 m0, s52
    s_nop 0
    buffer_load_dwordx4 v3, s[36:39], s53 offen lds
    s_add_u32 s52, s55, 15360
    s_add_u32 s53, s54, 122880
    s_mov_b32 m0, s52
    s_nop 0
    buffer_load_dwordx4 v3, s[36:39], s53 offen lds
A_join:
    s_and_b32 s7, s6, 1
    v_and_b32 v4, 31, v1
    v_lshrrev_b32 v5, 5, v1
    v_and_b32 v16, 15, v1
    v_xor_b32 v16, v16, v5
    v_lshlrev_b32 v16, 4, v16
    v_lshl_add_u32 v16, v4, 10, v16
    s_lshl_b32 s52, s7, 15
    s_add_u32 s52, s52, 0
    v_add_u32 v16, s52, v16
    v_xor_b32 v17, 32, v16
    v_xor_b32 v18, 64, v16
    v_xor_b32 v19, 96, v16
    v_xor_b32 v20, 128, v16
    v_xor_b32 v21, 160, v16
    v_xor_b32 v22, 192, v16
    v_xor_b32 v23, 224, v16
    v_bfe_u32 v7, v1, 2, 2
    v_and_b32 v8, 3, v1
    v_bfe_u32 v9, v1, 4, 1
    v_lshl_add_u32 v10, v5, 3, v7
    s_lshr_b32 s50, s6, 1
    v_lshrrev_b32 v11, 1, v7
    v_xor_b32 v11, s50, v11
    v_lshlrev_b32 v12, 7, v10
    v_lshl_add_u32 v12, v11, 6, v12
    v_lshl_add_u32 v12, v9, 5, v12
    v_lshl_add_u32 v12, v8, 3, v12
    v_add_u32 v12, 81920, v12
    v_lshlrev_b32 v13, 4, v5
    v_add_u32 v13, 161024, v13
    s_lshl_b32 s52, s6, 8
    s_add_u32 s52, s52, 159744
    v_lshlrev_b32 v14, 2, v1
    v_add_u32 v14, s52, v14
    v_mov_b32 v15, 0xff800000
    ds_write_b32 v14, v15
    s_cmp_lg_u32 s50, 0
    s_cbranch_scc1 A_qng0
    ds_read_b128 v[68:71], v16 offset:0
    ds_read_b128 v[64:67], v13 offset:0
    ds_read_b128 v[76:79], v17 offset:0
    ds_read_b128 v[72:75], v13 offset:32
    ds_read_b128 v[84:87], v18 offset:0
    ds_read_b128 v[80:83], v13 offset:64
    ds_read_b128 v[92:95], v19 offset:0
    ds_read_b128 v[88:91], v13 offset:96
    ds_read_b128 v[100:103], v20 offset:0
    ds_read_b128 v[96:99], v13 offset:128
    ds_read_b128 v[108:111], v21 offset:0
    ds_read_b128 v[104:107], v13 offset:160
    s_waitcnt lgkmcnt(10)
    v_mfma_f32_32x32x16_bf16 v[32:47], v[64:67], v[68:71], 0
    ds_read_b128 v[68:71], v22 offset:0
    ds_read_b128 v[64:67], v13 offset:192
    s_waitcnt lgkmcnt(10)
    v_mfma_f32_32x32x16_bf16 v[32:47], v[72:75], v[76:79], v[32:47]
    ds_read_b128 v[76:79], v23 offset:0
    ds_read_b128 v[72:75], v13 offset:224
    s_waitcnt lgkmcnt(10)
    v_mfma_f32_32x32x16_bf16 v[32:47], v[80:83], v[84:87], v[32:47]
    ds_read_b128 v[84:87], v16 offset:256
    ds_read_b128 v[80:83], v13 offset:256
    s_waitcnt lgkmcnt(10)
    v_mfma_f32_32x32x16_bf16 v[32:47], v[88:91], v[92:95], v[32:47]
    ds_read_b128 v[92:95], v17 offset:256
    ds_read_b128 v[88:91], v13 offset:288
    s_waitcnt lgkmcnt(10)
    v_mfma_f32_32x32x16_bf16 v[32:47], v[96:99], v[100:103], v[32:47]
    ds_read_b128 v[100:103], v18 offset:256
    ds_read_b128 v[96:99], v13 offset:320
    s_waitcnt lgkmcnt(10)
    v_mfma_f32_32x32x16_bf16 v[32:47], v[104:107], v[108:111], v[32:47]
    ds_read_b128 v[108:111], v19 offset:256
    ds_read_b128 v[104:107], v13 offset:352
    s_waitcnt lgkmcnt(10)
    v_mfma_f32_32x32x16_bf16 v[32:47], v[64:67], v[68:71], v[32:47]
    ds_read_b128 v[68:71], v20 offset:256
    ds_read_b128 v[64:67], v13 offset:384
    s_waitcnt lgkmcnt(10)
    v_mfma_f32_32x32x16_bf16 v[32:47], v[72:75], v[76:79], v[32:47]
    ds_read_b128 v[76:79], v21 offset:256
    ds_read_b128 v[72:75], v13 offset:416
    s_waitcnt lgkmcnt(10)
    v_mfma_f32_32x32x16_bf16 v[32:47], v[80:83], v[84:87], v[32:47]
    ds_read_b128 v[84:87], v22 offset:256
    ds_read_b128 v[80:83], v13 offset:448
    s_waitcnt lgkmcnt(10)
    v_mfma_f32_32x32x16_bf16 v[32:47], v[88:91], v[92:95], v[32:47]
    ds_read_b128 v[92:95], v23 offset:256
    ds_read_b128 v[88:91], v13 offset:480
    s_waitcnt lgkmcnt(10)
    v_mfma_f32_32x32x16_bf16 v[32:47], v[96:99], v[100:103], v[32:47]
    ds_read_b128 v[100:103], v16 offset:512
    ds_read_b128 v[96:99], v13 offset:512
    s_waitcnt lgkmcnt(10)
    v_mfma_f32_32x32x16_bf16 v[32:47], v[104:107], v[108:111], v[32:47]
    ds_read_b128 v[108:111], v17 offset:512
    ds_read_b128 v[104:107], v13 offset:544
    s_waitcnt lgkmcnt(10)
    v_mfma_f32_32x32x16_bf16 v[32:47], v[64:67], v[68:71], v[32:47]
    ds_read_b128 v[68:71], v18 offset:512
    ds_read_b128 v[64:67], v13 offset:576
    s_waitcnt lgkmcnt(10)
    v_mfma_f32_32x32x16_bf16 v[32:47], v[72:75], v[76:79], v[32:47]
    ds_read_b128 v[76:79], v19 offset:512
    ds_read_b128 v[72:75], v13 offset:608
    s_waitcnt lgkmcnt(10)
    v_mfma_f32_32x32x16_bf16 v[32:47], v[80:83], v[84:87], v[32:47]
    ds_read_b128 v[84:87], v20 offset:512
    ds_read_b128 v[80:83], v13 offset:640
    s_waitcnt lgkmcnt(10)
    v_mfma_f32_32x32x16_bf16 v[32:47], v[88:91], v[92:95], v[32:47]
    ds_read_b128 v[92:95], v21 offset:512
    ds_read_b128 v[88:91], v13 offset:672
    s_waitcnt lgkmcnt(10)
    v_mfma_f32_32x32x16_bf16 v[32:47], v[96:99], v[100:103], v[32:47]
    ds_read_b128 v[100:103], v22 offset:512
    ds_read_b128 v[96:99], v13 offset:704
    s_waitcnt lgkmcnt(10)
    v_mfma_f32_32x32x16_bf16 v[32:47], v[104:107], v[108:111], v[32:47]
    ds_read_b128 v[108:111], v23 offset:512
    ds_read_b128 v[104:107], v13 offset:736
    s_waitcnt lgkmcnt(10)
    v_mfma_f32_32x32x16_bf16 v[32:47], v[64:67], v[68:71], v[32:47]
    ds_read_b128 v[68:71], v16 offset:768
    ds_read_b128 v[64:67], v13 offset:768
    s_waitcnt lgkmcnt(10)
    v_mfma_f32_32x32x16_bf16 v[32:47], v[72:75], v[76:79], v[32:47]
    ds_read_b128 v[76:79], v17 offset:768
    ds_read_b128 v[72:75], v13 offset:800
    s_waitcnt lgkmcnt(10)
    v_mfma_f32_32x32x16_bf16 v[32:47], v[80:83], v[84:87], v[32:47]
    ds_read_b128 v[84:87], v18 offset:768
    ds_read_b128 v[80:83], v13 offset:832
    s_waitcnt lgkmcnt(10)
    v_mfma_f32_32x32x16_bf16 v[32:47], v[88:91], v[92:95], v[32:47]
    ds_read_b128 v[92:95], v19 offset:768
    ds_read_b128 v[88:91], v13 offset:864
    s_waitcnt lgkmcnt(10)
    v_mfma_f32_32x32x16_bf16 v[32:47], v[96:99], v[100:103], v[32:47]
    ds_read_b128 v[100:103], v20 offset:768
    ds_read_b128 v[96:99], v13 offset:896
    s_waitcnt lgkmcnt(10)
    v_mfma_f32_32x32x16_bf16 v[32:47], v[104:107], v[108:111], v[32:47]
    ds_read_b128 v[108:111], v21 offset:768
    ds_read_b128 v[104:107], v13 offset:928
    s_waitcnt lgkmcnt(10)
    v_mfma_f32_32x32x16_bf16 v[32:47], v[64:67], v[68:71], v[32:47]
    ds_read_b128 v[68:71], v22 offset:768
    ds_read_b128 v[64:67], v13 offset:960
    s_waitcnt lgkmcnt(10)
    v_mfma_f32_32x32x16_bf16 v[32:47], v[72:75], v[76:79], v[32:47]
    ds_read_b128 v[76:79], v23 offset:768
    ds_read_b128 v[72:75], v13 offset:992
    s_waitcnt lgkmcnt(10)
    v_mfma_f32_32x32x16_bf16 v[32:47], v[80:83], v[84:87], v[32:47]
    s_waitcnt lgkmcnt(8)
    v_mfma_f32_32x32x16_bf16 v[32:47], v[88:91], v[92:95], v[32:47]
    s_waitcnt lgkmcnt(6)
    v_mfma_f32_32x32x16_bf16 v[32:47], v[96:99], v[100:103], v[32:47]
    s_waitcnt lgkmcnt(4)
    v_mfma_f32_32x32x16_bf16 v[32:47], v[104:107], v[108:111], v[32:47]
    s_waitcnt lgkmcnt(2)
    v_mfma_f32_32x32x16_bf16 v[32:47], v[64:67], v[68:71], v[32:47]
    s_waitcnt lgkmcnt(0)
    v_mfma_f32_32x32x16_bf16 v[32:47], v[72:75], v[76:79], v[32:47]
    s_nop 15
    s_nop 3
    s_lshl_b32 s52, s7, 7
    s_add_u32 s52, s52, 160768
    v_lshlrev_b32 v26, 2, v4
    v_add_u32 v26, s52, v26
    v_mul_f32 v24, 0xbfb8aa3b, v32
    v_exp_f32 v24, v24
    s_nop 0
    v_add_f32 v24, 1.0, v24
    v_rcp_f32 v24, v24
    s_nop 0
    ds_write_b32 v26, v24
    v_mov_b32 v14, 162084
    v_mov_b32 v15, 1
    s_mov_b64 exec, 1
    ds_add_u32 v14, v15
    s_mov_b64 exec, -1
A_qng0:
    s_mov_b32 s40, 0x0000ffff
    s_mov_b32 s41, 0x0000ffff
    v_mbcnt_lo_u32_b32 v252, -1, 0
    v_mbcnt_hi_u32_b32 v252, -1, v252
    v_and_b32 v252, 27, v252
    v_cmp_eq_u32 vcc, 16, v252
    v_mov_b32 v254, 0x3f803f80
    v_cndmask_b32 v254, 0, v254, vcc
    v_mov_b64 v[200:201], 0
    v_mov_b64 v[202:203], 0
    s_not_b64 exec, s[40:41]
    v_pk_mov_b32 v[112:113], v[254:255], v[254:255] op_sel:[0,0]
    v_pk_mov_b32 v[114:115], v[254:255], v[254:255] op_sel:[0,0]
    v_pk_mov_b32 v[116:117], v[254:255], v[254:255] op_sel:[0,0]
    v_pk_mov_b32 v[118:119], v[254:255], v[254:255] op_sel:[0,0]
    v_pk_mov_b32 v[120:121], v[254:255], v[254:255] op_sel:[0,0]
    v_pk_mov_b32 v[122:123], v[254:255], v[254:255] op_sel:[0,0]
    v_pk_mov_b32 v[124:125], v[254:255], v[254:255] op_sel:[0,0]
    v_pk_mov_b32 v[126:127], v[254:255], v[254:255] op_sel:[0,0]
    v_pk_mov_b32 v[128:129], v[254:255], v[254:255] op_sel:[0,0]
    v_pk_mov_b32 v[130:131], v[254:255], v[254:255] op_sel:[0,0]
    v_pk_mov_b32 v[132:133], v[254:255], v[254:255] op_sel:[0,0]
    v_pk_mov_b32 v[134:135], v[254:255], v[254:255] op_sel:[0,0]
    v_pk_mov_b32 v[136:137], v[254:255], v[254:255] op_sel:[0,0]
    v_pk_mov_b32 v[138:139], v[254:255], v[254:255] op_sel:[0,0]
    v_pk_mov_b32 v[140:141], v[254:255], v[254:255] op_sel:[0,0]
    v_pk_mov_b32 v[142:143], v[254:255], v[254:255] op_sel:[0,0]
    v_pk_mov_b32 v[144:145], v[254:255], v[254:255] op_sel:[0,0]
    v_pk_mov_b32 v[146:147], v[254:255], v[254:255] op_sel:[0,0]
    v_pk_mov_b32 v[148:149], v[254:255], v[254:255] op_sel:[0,0]
    v_pk_mov_b32 v[150:151], v[254:255], v[254:255] op_sel:[0,0]
    v_pk_mov_b32 v[152:153], v[254:255], v[254:255] op_sel:[0,0]
    v_pk_mov_b32 v[154:155], v[254:255], v[254:255] op_sel:[0,0]
    v_pk_mov_b32 v[156:157], v[254:255], v[254:255] op_sel:[0,0]
    v_pk_mov_b32 v[158:159], v[254:255], v[254:255] op_sel:[0,0]
    v_pk_mov_b32 v[160:161], v[254:255], v[254:255] op_sel:[0,0]
    v_pk_mov_b32 v[162:163], v[254:255], v[254:255] op_sel:[0,0]
    v_pk_mov_b32 v[164:165], v[254:255], v[254:255] op_sel:[0,0]
    v_pk_mov_b32 v[166:167], v[254:255], v[254:255] op_sel:[0,0]
    v_pk_mov_b32 v[168:169], v[254:255], v[254:255] op_sel:[0,0]
    v_pk_mov_b32 v[170:171], v[254:255], v[254:255] op_sel:[0,0]
    v_pk_mov_b32 v[172:173], v[254:255], v[254:255] op_sel:[0,0]
    v_pk_mov_b32 v[174:175], v[254:255], v[254:255] op_sel:[0,0]
    v_pk_mov_b32 v[176:177], v[254:255], v[254:255] op_sel:[0,0]
    v_pk_mov_b32 v[178:179], v[254:255], v[254:255] op_sel:[0,0]
    v_pk_mov_b32 v[180:181], v[254:255], v[254:255] op_sel:[0,0]
    v_pk_mov_b32 v[182:183], v[254:255], v[254:255] op_sel:[0,0]
    v_pk_mov_b32 v[184:185], v[254:255], v[254:255] op_sel:[0,0]
    v_pk_mov_b32 v[186:187], v[254:255], v[254:255] op_sel:[0,0]
    v_pk_mov_b32 v[188:189], v[254:255], v[254:255] op_sel:[0,0]
    v_pk_mov_b32 v[190:191], v[254:255], v[254:255] op_sel:[0,0]
    v_pk_mov_b32 v[192:193], v[254:255], v[254:255] op_sel:[0,0]
    v_pk_mov_b32 v[194:195], v[254:255], v[254:255] op_sel:[0,0]
    v_pk_mov_b32 v[196:197], v[254:255], v[254:255] op_sel:[0,0]
    v_pk_mov_b32 v[198:199], v[254:255], v[254:255] op_sel:[0,0]
    v_pk_mov_b32 v[200:201], v[254:255], v[254:255] op_sel:[0,0]
    v_pk_mov_b32 v[202:203], v[254:255], v[254:255] op_sel:[0,0]
    s_mov_b64 exec, -1
    s_waitcnt vmcnt(0)
    v_mov_b32 v14, 162048
    v_mov_b32 v15, 1
    s_mov_b64 exec, 1
    ds_add_u32 v14, v15
    s_mov_b64 exec, -1
    v_mov_b32 v14, 162048
lw_2:
    ds_read_b32 v15, v14
    s_waitcnt lgkmcnt(0)
    v_readfirstlane_b32 s52, v15
    s_cmp_ge_u32 s52, 4
    s_cbranch_scc1 lw_2_d
    s_sleep 1
    s_add_u32 s58, s58, 1
    s_cmp_lt_u32 s58, 200000
    s_cbranch_scc1 lw_2
lw_2_d:
    v_mov_b32 v215, 128
    s_cmp_lg_u32 s6, 3
    s_cbranch_scc1 A_nrl
    global_load_dword v214, v215, s[48:49] sc1
A_nrl:
    ds_read_b128 v[68:71], v16 offset:0
    ds_read_b64_tr_b16 v[64:65], v12 offset:0
    ds_read_b64_tr_b16 v[66:67], v12 offset:512
    ds_read_b128 v[76:79], v17 offset:0
    ds_read_b64_tr_b16 v[72:73], v12 offset:2048
    ds_read_b64_tr_b16 v[74:75], v12 offset:2560
    ds_read_b128 v[84:87], v18 offset:0
    ds_read_b64_tr_b16 v[80:81], v12 offset:4096
    ds_read_b64_tr_b16 v[82:83], v12 offset:4608
    ds_read_b128 v[92:95], v19 offset:0
    ds_read_b64_tr_b16 v[88:89], v12 offset:6144
    ds_read_b64_tr_b16 v[90:91], v12 offset:6656
    ds_read_b128 v[100:103], v20 offset:0
    ds_read_b64_tr_b16 v[96:97], v12 offset:8192
    ds_read_b64_tr_b16 v[98:99], v12 offset:8704
    ds_read_b128 v[108:111], v21 offset:0
    ds_read_b64_tr_b16 v[104:105], v12 offset:10240
    ds_read_b64_tr_b16 v[106:107], v12 offset:10752
    s_waitcnt lgkmcnt(15)
    v_mfma_f32_32x32x16_bf16 v[32:47], v[64:67], v[68:71], 0
    ds_read_b128 v[68:71], v22 offset:0
    ds_read_b64_tr_b16 v[64:65], v12 offset:12288
    ds_read_b64_tr_b16 v[66:67], v12 offset:12800
    s_waitcnt lgkmcnt(15)
    v_mfma_f32_32x32x16_bf16 v[32:47], v[72:75], v[76:79], v[32:47]
    ds_read_b128 v[76:79], v23 offset:0
    ds_read_b64_tr_b16 v[72:73], v12 offset:14336
    ds_read_b64_tr_b16 v[74:75], v12 offset:14848
    s_waitcnt lgkmcnt(15)
    v_mfma_f32_32x32x16_bf16 v[32:47], v[80:83], v[84:87], v[32:47]
    ds_read_b128 v[84:87], v16 offset:256
    ds_read_b64_tr_b16 v[80:81], v12 offset:16384
    ds_read_b64_tr_b16 v[82:83], v12 offset:16896
    s_waitcnt lgkmcnt(15)
    v_mfma_f32_32x32x16_bf16 v[32:47], v[88:91], v[92:95], v[32:47]
    ds_read_b128 v[92:95], v17 offset:256
    ds_read_b64_tr_b16 v[88:89], v12 offset:18432
    ds_read_b64_tr_b16 v[90:91], v12 offset:18944
    s_waitcnt lgkmcnt(15)
    v_mfma_f32_32x32x16_bf16 v[32:47], v[96:99], v[100:103], v[32:47]
    ds_read_b128 v[100:103], v18 offset:256
    ds_read_b64_tr_b16 v[96:97], v12 offset:20480
    ds_read_b64_tr_b16 v[98:99], v12 offset:20992
    s_waitcnt lgkmcnt(15)
    v_mfma_f32_32x32x16_bf16 v[32:47], v[104:107], v[108:111], v[32:47]
    ds_read_b128 v[108:111], v19 offset:256
    ds_read_b64_tr_b16 v[104:105], v12 offset:22528
    ds_read_b64_tr_b16 v[106:107], v12 offset:23040
    s_waitcnt lgkmcnt(15)
    v_mfma_f32_32x32x16_bf16 v[32:47], v[64:67], v[68:71], v[32:47]
    ds_read_b128 v[68:71], v20 offset:256
    ds_read_b64_tr_b16 v[64:65], v12 offset:24576
    ds_read_b64_tr_b16 v[66:67], v12 offset:25088
    s_waitcnt lgkmcnt(15)
    v_mfma_f32_32x32x16_bf16 v[32:47], v[72:75], v[76:79], v[32:47]
    ds_read_b128 v[76:79], v21 offset:256
    ds_read_b64_tr_b16 v[72:73], v12 offset:26624
    ds_read_b64_tr_b16 v[74:75], v12 offset:27136
    s_waitcnt lgkmcnt(15)
    v_mfma_f32_32x32x16_bf16 v[32:47], v[80:83], v[84:87], v[32:47]
    ds_read_b128 v[84:87], v22 offset:256
    ds_read_b64_tr_b16 v[80:81], v12 offset:28672
    ds_read_b64_tr_b16 v[82:83], v12 offset:29184
    s_waitcnt lgkmcnt(15)
    v_mfma_f32_32x32x16_bf16 v[32:47], v[88:91], v[92:95], v[32:47]
    ds_read_b128 v[92:95], v23 offset:256
    ds_read_b64_tr_b16 v[88:89], v12 offset:30720
    ds_read_b64_tr_b16 v[90:91], v12 offset:31232
    s_waitcnt lgkmcnt(15)
    v_mfma_f32_32x32x16_bf16 v[32:47], v[96:99], v[100:103], v[32:47]
    ds_read_b128 v[100:103], v16 offset:512
    ds_read_b64_tr_b16 v[96:97], v12 offset:32768
    ds_read_b64_tr_b16 v[98:99], v12 offset:33280
    s_waitcnt lgkmcnt(15)
    v_mfma_f32_32x32x16_bf16 v[32:47], v[104:107], v[108:111], v[32:47]
    ds_read_b128 v[108:111], v17 offset:512
    ds_read_b64_tr_b16 v[104:105], v12 offset:34816
    ds_read_b64_tr_b16 v[106:107], v12 offset:35328
    s_waitcnt lgkmcnt(15)
    v_mfma_f32_32x32x16_bf16 v[32:47], v[64:67], v[68:71], v[32:47]
    ds_read_b128 v[68:71], v18 offset:512
    ds_read_b64_tr_b16 v[64:65], v12 offset:36864
    ds_read_b64_tr_b16 v[66:67], v12 offset:37376
    s_waitcnt lgkmcnt(15)
    v_mfma_f32_32x32x16_bf16 v[32:47], v[72:75], v[76:79], v[32:47]
    ds_read_b128 v[76:79], v19 offset:512
    ds_read_b64_tr_b16 v[72:73], v12 offset:38912
    ds_read_b64_tr_b16 v[74:75], v12 offset:39424
    s_waitcnt lgkmcnt(15)
    v_mfma_f32_32x32x16_bf16 v[32:47], v[80:83], v[84:87], v[32:47]
    ds_read_b128 v[84:87], v20 offset:512
    ds_read_b64_tr_b16 v[80:81], v12 offset:40960
    ds_read_b64_tr_b16 v[82:83], v12 offset:41472
    s_waitcnt lgkmcnt(15)
    v_mfma_f32_32x32x16_bf16 v[32:47], v[88:91], v[92:95], v[32:47]
    ds_read_b128 v[92:95], v21 offset:512
    ds_read_b64_tr_b16 v[88:89], v12 offset:43008
    ds_read_b64_tr_b16 v[90:91], v12 offset:43520
    s_waitcnt lgkmcnt(15)
    v_mfma_f32_32x32x16_bf16 v[32:47], v[96:99], v[100:103], v[32:47]
    ds_read_b128 v[100:103], v22 offset:512
    ds_read_b64_tr_b16 v[96:97], v12 offset:45056
    ds_read_b64_tr_b16 v[98:99], v12 offset:45568
    s_waitcnt lgkmcnt(15)
    v_mfma_f32_32x32x16_bf16 v[32:47], v[104:107], v[108:111], v[32:47]
    ds_read_b128 v[108:111], v23 offset:512
    ds_read_b64_tr_b16 v[104:105], v12 offset:47104
    ds_read_b64_tr_b16 v[106:107], v12 offset:47616
    s_waitcnt lgkmcnt(15)
    v_mfma_f32_32x32x16_bf16 v[32:47], v[64:67], v[68:71], v[32:47]
    ds_read_b128 v[68:71], v16 offset:768
    ds_read_b64_tr_b16 v[64:65], v12 offset:49152
    ds_read_b64_tr_b16 v[66:67], v12 offset:49664
    s_waitcnt lgkmcnt(15)
    v_mfma_f32_32x32x16_bf16 v[32:47], v[72:75], v[76:79], v[32:47]
    ds_read_b128 v[76:79], v17 offset:768
    ds_read_b64_tr_b16 v[72:73], v12 offset:51200
    ds_read_b64_tr_b16 v[74:75], v12 offset:51712
    s_waitcnt lgkmcnt(15)
    v_mfma_f32_32x32x16_bf16 v[32:47], v[80:83], v[84:87], v[32:47]
    ds_read_b128 v[84:87], v18 offset:768
    ds_read_b64_tr_b16 v[80:81], v12 offset:53248
    ds_read_b64_tr_b16 v[82:83], v12 offset:53760
    s_waitcnt lgkmcnt(15)
    v_mfma_f32_32x32x16_bf16 v[32:47], v[88:91], v[92:95], v[32:47]
    ds_read_b128 v[92:95], v19 offset:768
    ds_read_b64_tr_b16 v[88:89], v12 offset:55296
    ds_read_b64_tr_b16 v[90:91], v12 offset:55808
    s_waitcnt lgkmcnt(15)
    v_mfma_f32_32x32x16_bf16 v[32:47], v[96:99], v[100:103], v[32:47]
    ds_read_b128 v[100:103], v20 offset:768
    ds_read_b64_tr_b16 v[96:97], v12 offset:57344
    ds_read_b64_tr_b16 v[98:99], v12 offset:57856
    s_waitcnt lgkmcnt(15)
    v_mfma_f32_32x32x16_bf16 v[32:47], v[104:107], v[108:111], v[32:47]
    ds_read_b128 v[108:111], v21 offset:768
    ds_read_b64_tr_b16 v[104:105], v12 offset:59392
    ds_read_b64_tr_b16 v[106:107], v12 offset:59904
    s_waitcnt lgkmcnt(15)
    v_mfma_f32_32x32x16_bf16 v[32:47], v[64:67], v[68:71], v[32:47]
    ds_read_b128 v[68:71], v22 offset:768
    ds_read_b64_tr_b16 v[64:65], v12 offset:61440
    ds_read_b64_tr_b16 v[66:67], v12 offset:61952
    s_waitcnt lgkmcnt(15)
    v_mfma_f32_32x32x16_bf16 v[32:47], v[72:75], v[76:79], v[32:47]
    ds_read_b128 v[76:79], v23 offset:768
    ds_read_b64_tr_b16 v[72:73], v12 offset:63488
    ds_read_b64_tr_b16 v[74:75], v12 offset:64000
    s_waitcnt lgkmcnt(15)
    v_mfma_f32_32x32x16_bf16 v[32:47], v[80:83], v[84:87], v[32:47]
    s_waitcnt lgkmcnt(12)
    v_mfma_f32_32x32x16_bf16 v[32:47], v[88:91], v[92:95], v[32:47]
    s_waitcnt lgkmcnt(9)
    v_mfma_f32_32x32x16_bf16 v[32:47], v[96:99], v[100:103], v[32:47]
    s_waitcnt lgkmcnt(6)
    v_mfma_f32_32x32x16_bf16 v[32:47], v[104:107], v[108:111], v[32:47]
    s_waitcnt lgkmcnt(3)
    v_mfma_f32_32x32x16_bf16 v[32:47], v[64:67], v[68:71], v[32:47]
    s_waitcnt lgkmcnt(0)
    v_mfma_f32_32x32x16_bf16 v[32:47], v[72:75], v[76:79], v[32:47]
    s_nop 15
    s_nop 3
    v_cvt_pk_bf16_f32 v64, v32, v33
    v_cvt_pk_bf16_f32 v65, v34, v35
    v_cvt_pk_bf16_f32 v66, v36, v37
    v_cvt_pk_bf16_f32 v67, v38, v39
    v_cvt_pk_bf16_f32 v68, v40, v41
    v_cvt_pk_bf16_f32 v69, v42, v43
    v_cvt_pk_bf16_f32 v70, v44, v45
    v_cvt_pk_bf16_f32 v71, v46, v47
    s_lshl_b32 s52, s50, 12
    s_lshl_b32 s53, s7, 10
    s_add_u32 s52, s52, s53
    s_add_u32 s52, s52, 147456
    v_add_u32 v26, s52, v2
    ds_write_b128 v26, v[64:67]
    ds_write_b128 v26, v[68:71] offset:2048
    v_mul_f32 v24, v32, v32
    v_mul_f32 v25, v40, v40
    v_fmac_f32 v24, v33, v33
    v_fmac_f32 v25, v41, v41
    v_fmac_f32 v24, v34, v34
    v_fmac_f32 v25, v42, v42
    v_fmac_f32 v24, v35, v35
    v_fmac_f32 v25, v43, v43
    v_fmac_f32 v24, v36, v36
    v_fmac_f32 v25, v44, v44
    v_fmac_f32 v24, v37, v37
    v_fmac_f32 v25, v45, v45
    v_fmac_f32 v24, v38, v38
    v_fmac_f32 v25, v46, v46
    v_fmac_f32 v24, v39, v39
    v_fmac_f32 v25, v47, v47
    v_mov_b32 v26, v24
    s_nop 1
    v_permlane32_swap_b32 v24, v26
    s_nop 1
    v_add_f32 v24, v24, v26
    v_mov_b32 v27, v25
    s_nop 1
    v_permlane32_swap_b32 v25, v27
    s_nop 1
    v_add_f32 v25, v25, v27
    v_max_f32 v24, v24, v25
    s_nop 1
    v_max_f32_dpp v24, v24, v24 row_shr:1 row_mask:0xf bank_mask:0xf
    s_nop 1
    v_max_f32_dpp v24, v24, v24 row_shr:2 row_mask:0xf bank_mask:0xf
    s_nop 1
    v_max_f32_dpp v24, v24, v24 row_shr:4 row_mask:0xf bank_mask:0xf
    s_nop 1
    v_max_f32_dpp v24, v24, v24 row_shr:8 row_mask:0xf bank_mask:0xf
    s_nop 1
    v_max_f32_dpp v24, v24, v24 row_bcast:15 row_mask:0xa bank_mask:0xf
    s_nop 1
    v_max_f32_dpp v24, v24, v24 row_bcast:31 row_mask:0xc bank_mask:0xf
    v_mov_b32 v25, 162124
    s_mov_b32 exec_lo, 0
    s_mov_b32 exec_hi, 0x80000000
    ds_max_u32 v25, v24
    s_mov_b64 exec, -1
    v_mov_b32 v14, 162052
    v_mov_b32 v15, 1
    s_mov_b64 exec, 1
    ds_add_u32 v14, v15
    s_mov_b64 exec, -1
A_qng:
    v_mbcnt_lo_u32_b32 v252, -1, 0
    v_mbcnt_hi_u32_b32 v252, -1, v252
    s_cmp_lg_u32 s6, 3
    s_cbranch_scc1 A_nopoll
    s_and_b32 s52, s4, 31
    s_mul_i32 s52, s52, 256
    s_add_u32 s52, s52, 2269184
    v_mov_b32 v216, s52
A_zp:
    s_waitcnt vmcnt(0)
    v_readfirstlane_b32 s52, v214
    s_cmp_lg_u32 s52, 0
    s_cbranch_scc1 A_zpd
    global_load_dword v214, v215, s[48:49] sc1
    s_sleep 1
    s_add_u32 s58, s58, 1
    s_cmp_lt_u32 s58, 200000
    s_cbranch_scc1 A_zp
A_zpd:
    s_mov_b64 exec, 1
A_poll:
    global_load_dword v204, v216, s[30:31] sc1
    s_waitcnt vmcnt(0)
    v_readfirstlane_b32 s52, v204
    s_cmp_ge_u32 s52, 32
    s_cbranch_scc1 A_polld
    s_sleep 2
    s_add_u32 s58, s58, 1
    s_cmp_lt_u32 s58, 200000
    s_cbranch_scc1 A_poll
A_polld:
    s_mov_b64 exec, -1
    v_mov_b32 v206, 162112
    v_mov_b32 v207, 1
    ds_write_b32 v206, v207
A_nopoll:
    s_mov_b32 s40, 0x0000ffff
    s_mov_b32 s41, 0x0000ffff
    v_mbcnt_lo_u32_b32 v252, -1, 0
    v_mbcnt_hi_u32_b32 v252, -1, v252
    v_and_b32 v252, 27, v252
    v_cmp_eq_u32 vcc, 16, v252
    v_mov_b32 v254, 0x3f803f80
    v_cndmask_b32 v254, 0, v254, vcc
    s_not_b64 exec, s[40:41]
    v_pk_mov_b32 v[76:77], v[254:255], v[254:255] op_sel:[0,0]
    v_pk_mov_b32 v[78:79], v[254:255], v[254:255] op_sel:[0,0]
    v_pk_mov_b32 v[80:81], v[254:255], v[254:255] op_sel:[0,0]
    v_pk_mov_b32 v[82:83], v[254:255], v[254:255] op_sel:[0,0]
    v_pk_mov_b32 v[84:85], v[254:255], v[254:255] op_sel:[0,0]
    v_pk_mov_b32 v[86:87], v[254:255], v[254:255] op_sel:[0,0]
    v_pk_mov_b32 v[88:89], v[254:255], v[254:255] op_sel:[0,0]
    v_pk_mov_b32 v[90:91], v[254:255], v[254:255] op_sel:[0,0]
    v_pk_mov_b32 v[92:93], v[254:255], v[254:255] op_sel:[0,0]
    v_pk_mov_b32 v[94:95], v[254:255], v[254:255] op_sel:[0,0]
    v_pk_mov_b32 v[96:97], v[254:255], v[254:255] op_sel:[0,0]
    v_pk_mov_b32 v[98:99], v[254:255], v[254:255] op_sel:[0,0]
    v_pk_mov_b32 v[100:101], v[254:255], v[254:255] op_sel:[0,0]
    v_pk_mov_b32 v[102:103], v[254:255], v[254:255] op_sel:[0,0]
    v_pk_mov_b32 v[104:105], v[254:255], v[254:255] op_sel:[0,0]
    v_pk_mov_b32 v[106:107], v[254:255], v[254:255] op_sel:[0,0]
    v_pk_mov_b32 v[108:109], v[254:255], v[254:255] op_sel:[0,0]
    v_pk_mov_b32 v[110:111], v[254:255], v[254:255] op_sel:[0,0]
    s_mov_b64 exec, -1
    v_mov_b32 v3, 0xdddddddd
    v_mbcnt_lo_u32_b32 v252, -1, 0
    v_mbcnt_hi_u32_b32 v252, -1, v252
    v_lshlrev_b32 v253, 4, v252
    s_lshl_b32 s52, s6, 14
    s_add_u32 s52, s52, 81920
    v_add_u32 v0, s52, v253
    v_add_u32 v2, 147456, v253
    v_and_b32 v6, 31, v252
    v_lshlrev_b32 v6, 2, v6
    s_lshl_b32 s52, s6, 10
    s_add_u32 s52, s52, 155648
    v_add_u32 v1, s52, v6
    v_add_u32 v6, 159744, v6
    v_mov_b64 v[236:237], 0
    v_mov_b64 v[238:239], 0
    v_mov_b64 v[240:241], 0
    v_mov_b64 v[242:243], 0
    v_mov_b64 v[244:245], 0
    v_mov_b64 v[246:247], 0
    v_mov_b64 v[248:249], 0
    v_mov_b64 v[250:251], 0
    v_mov_b64 v[228:229], 0
    v_mov_b64 v[230:231], 0
    v_mov_b64 v[232:233], 0
    v_mov_b64 v[234:235], 0
    s_mov_b32 s60, 0
    s_lshl_b32 s52, s6, 14
    s_add_u32 s8, s52, 2097152
    s_add_u32 s12, s52, 2162688
    s_add_u32 s9, s52, 2101248
    s_add_u32 s13, s52, 2166784
    s_add_u32 s10, s52, 2105344
    s_add_u32 s14, s52, 2170880
    s_add_u32 s11, s52, 2109440
    s_add_u32 s15, s52, 2174976
    v_lshrrev_b32 v254, 5, v252
    v_and_b32 v255, 15, v252
    v_lshlrev_b32 v255, 4, v255
    v_lshl_add_u32 v7, v254, 8, v255
    v_mov_b32 v4, v253
    v_and_b32 v5, 31, v252
    v_lshlrev_b32 v5, 4, v5
    v_mov_b32 v254, 162112
lw_3:
    ds_read_b32 v255, v254
    s_waitcnt lgkmcnt(0)
    v_readfirstlane_b32 s52, v255
    s_cmp_ge_u32 s52, 1
    s_cbranch_scc1 lw_3_d
    s_sleep 1
    s_add_u32 s58, s58, 1
    s_cmp_lt_u32 s58, 200000
    s_cbranch_scc1 lw_3
lw_3_d:
    s_mov_b32 s52, 2260992
    buffer_load_dwordx4 v[204:207], v5, s[44:47], s52 offen sc1
    buffer_load_dwordx4 v[12:15], v4, s[44:47], s8 offen offset:0 sc1
    buffer_load_dwordx4 v[16:19], v4, s[44:47], s8 offen offset:1024 sc1
    s_mov_b64 exec, s[40:41]
    buffer_load_dwordx4 v[76:79], v7, s[44:47], s12 offen offset:0 sc1
    buffer_load_dwordx4 v[80:83], v7, s[44:47], s12 offen offset:512 sc1
    s_mov_b64 exec, -1
    buffer_load_dwordx4 v[20:23], v4, s[44:47], s8 offen offset:2048 sc1
    s_mov_b64 exec, s[40:41]
    buffer_load_dwordx4 v[84:87], v7, s[44:47], s12 offen offset:1024 sc1
    buffer_load_dwordx4 v[88:91], v7, s[44:47], s12 offen offset:1536 sc1
    s_mov_b64 exec, -1
    buffer_load_dwordx4 v[24:27], v4, s[44:47], s8 offen offset:3072 sc1
    s_mov_b64 exec, s[40:41]
    buffer_load_dwordx4 v[92:95], v7, s[44:47], s12 offen offset:2048 sc1
    buffer_load_dwordx4 v[96:99], v7, s[44:47], s12 offen offset:2560 sc1
    s_mov_b64 exec, -1
    buffer_load_dwordx4 v[28:31], v4, s[44:47], s9 offen offset:0 sc1
    s_mov_b64 exec, s[40:41]
    buffer_load_dwordx4 v[100:103], v7, s[44:47], s12 offen offset:3072 sc1
    buffer_load_dwordx4 v[104:107], v7, s[44:47], s12 offen offset:3584 sc1
    s_mov_b64 exec, -1
    v_mov_b32 v254, 162052
lw_4:
    ds_read_b32 v255, v254
    s_waitcnt lgkmcnt(0)
    v_readfirstlane_b32 s52, v255
    s_cmp_ge_u32 s52, 4
    s_cbranch_scc1 lw_4_d
    s_sleep 1
    s_add_u32 s58, s58, 1
    s_cmp_lt_u32 s58, 200000
    s_cbranch_scc1 lw_4
lw_4_d:
    ds_read_b128 v[8:11], v2
    v_mov_b32 v254, 162124
    ds_read_b32 v208, v254
    s_waitcnt vmcnt(13)
    v_max_f32 v204, v204, v206
    v_max_f32 v205, v205, v207
    s_nop 1
    v_max_f32_dpp v204, v204, v204 row_shr:1 row_mask:0xf bank_mask:0xf
    v_max_f32_dpp v205, v205, v205 row_shr:1 row_mask:0xf bank_mask:0xf
    s_nop 1
    v_max_f32_dpp v204, v204, v204 row_shr:2 row_mask:0xf bank_mask:0xf
    v_max_f32_dpp v205, v205, v205 row_shr:2 row_mask:0xf bank_mask:0xf
    s_nop 1
    v_max_f32_dpp v204, v204, v204 row_shr:4 row_mask:0xf bank_mask:0xf
    v_max_f32_dpp v205, v205, v205 row_shr:4 row_mask:0xf bank_mask:0xf
    s_nop 1
    v_max_f32_dpp v204, v204, v204 row_shr:8 row_mask:0xf bank_mask:0xf
    v_max_f32_dpp v205, v205, v205 row_shr:8 row_mask:0xf bank_mask:0xf
    s_nop 1
    v_max_f32_dpp v204, v204, v204 row_bcast:15 row_mask:0xa bank_mask:0xf
    v_max_f32_dpp v205, v205, v205 row_bcast:15 row_mask:0xa bank_mask:0xf
    s_nop 1
    v_max_f32_dpp v204, v204, v204 row_bcast:31 row_mask:0xc bank_mask:0xf
    v_max_f32_dpp v205, v205, v205 row_bcast:31 row_mask:0xc bank_mask:0xf
    s_nop 1
    v_readlane_b32 s52, v204, 63
    v_readlane_b32 s53, v205, 63
    s_waitcnt lgkmcnt(0)
    s_nop 1
    v_mul_f32 v204, s52, v208
    v_mov_b32 v205, s53
    v_cmp_nge_f32 vcc, 0x45440000, v204
    s_mov_b32 s54, 0x58800000
    v_cmp_nge_f32 s[52:53], s54, v205
    s_or_b64 s[52:53], vcc, s[52:53]
    s_cmp_lg_u64 s[52:53], 0
    s_cbranch_scc1 A_fallback
    s_mov_b32 s59, 4
    s_waitcnt vmcnt(12)
    v_mfma_f32_32x32x16_bf16 v[204:219], v[12:15], v[8:11], 0
    s_nop 7
    s_nop 3
    s_waitcnt vmcnt(9)
    s_setprio 2
    v_exp_f32 v204, v204
    v_exp_f32 v205, v205
    v_exp_f32 v206, v206
    v_exp_f32 v207, v207
    v_smfmac_f32_32x32x32_bf16 v[236:251], v[200:203], v[228:235], v3
    v_exp_f32 v208, v208
    v_exp_f32 v209, v209
    v_exp_f32 v210, v210
    v_mfma_f32_32x32x16_bf16 v[220:235], v[16:19], v[8:11], 0
    buffer_load_dwordx4 v[32:35], v4, s[44:47], s9 offen offset:1024 sc1
    s_mov_b64 exec, s[40:41]
    buffer_load_dwordx4 v[108:111], v7, s[44:47], s13 offen offset:0 sc1
    buffer_load_dwordx4 v[112:115], v7, s[44:47], s13 offen offset:512 sc1
    s_mov_b64 exec, -1
    v_exp_f32 v211, v211
    v_exp_f32 v212, v212
    v_exp_f32 v213, v213
    v_exp_f32 v214, v214
    v_exp_f32 v215, v215
    v_exp_f32 v216, v216
    v_smfmac_f32_32x32x32_bf16 v[236:251], v[76:79], v[204:211], v3
    s_setprio 0
    v_exp_f32 v217, v217
    v_exp_f32 v218, v218
    v_exp_f32 v219, v219
    s_waitcnt vmcnt(9)
    s_setprio 2
    v_exp_f32 v220, v220
    v_exp_f32 v221, v221
    v_exp_f32 v222, v222
    v_exp_f32 v223, v223
    v_smfmac_f32_32x32x32_bf16 v[236:251], v[80:83], v[212:219], v3
    v_exp_f32 v224, v224
    v_exp_f32 v225, v225
    v_exp_f32 v226, v226
    v_mfma_f32_32x32x16_bf16 v[204:219], v[20:23], v[8:11], 0
    buffer_load_dwordx4 v[36:39], v4, s[44:47], s9 offen offset:2048 sc1
    s_mov_b64 exec, s[40:41]
    buffer_load_dwordx4 v[116:119], v7, s[44:47], s13 offen offset:1024 sc1
    buffer_load_dwordx4 v[120:123], v7, s[44:47], s13 offen offset:1536 sc1
    s_mov_b64 exec, -1
    v_exp_f32 v227, v227
    v_exp_f32 v228, v228
    v_exp_f32 v229, v229
    v_smfmac_f32_32x32x32_bf16 v[236:251], v[84:87], v[220:227], v3
    s_setprio 0
    v_exp_f32 v230, v230
    v_exp_f32 v231, v231
    v_exp_f32 v232, v232
    v_exp_f32 v233, v233
    v_exp_f32 v234, v234
    v_exp_f32 v235, v235
    s_waitcnt vmcnt(9)
    s_setprio 2
    v_exp_f32 v204, v204
    v_exp_f32 v205, v205
    v_exp_f32 v206, v206
    v_exp_f32 v207, v207
    v_smfmac_f32_32x32x32_bf16 v[236:251], v[88:91], v[228:235], v3
    v_exp_f32 v208, v208
    v_exp_f32 v209, v209
    v_exp_f32 v210, v210
    v_mfma_f32_32x32x16_bf16 v[220:235], v[24:27], v[8:11], 0
    buffer_load_dwordx4 v[40:43], v4, s[44:47], s9 offen offset:3072 sc1
    s_mov_b64 exec, s[40:41]
    buffer_load_dwordx4 v[124:127], v7, s[44:47], s13 offen offset:2048 sc1
    buffer_load_dwordx4 v[128:131], v7, s[44:47], s13 offen offset:2560 sc1
    s_mov_b64 exec, -1
    v_exp_f32 v211, v211
    v_exp_f32 v212, v212
    v_exp_f32 v213, v213
    v_smfmac_f32_32x32x32_bf16 v[236:251], v[92:95], v[204:211], v3
    s_setprio 0
    v_exp_f32 v214, v214
    v_exp_f32 v215, v215
    v_exp_f32 v216, v216
    v_exp_f32 v217, v217
    v_exp_f32 v218, v218
    v_exp_f32 v219, v219
    s_waitcnt vmcnt(9)
    s_setprio 2
    v_exp_f32 v220, v220
    v_exp_f32 v221, v221
    v_exp_f32 v222, v222
    v_exp_f32 v223, v223
    v_smfmac_f32_32x32x32_bf16 v[236:251], v[96:99], v[212:219], v3
    v_exp_f32 v224, v224
    v_exp_f32 v225, v225
    v_exp_f32 v226, v226
    v_mfma_f32_32x32x16_bf16 v[204:219], v[28:31], v[8:11], 0
    buffer_load_dwordx4 v[44:47], v4, s[44:47], s10 offen offset:0 sc1
    s_mov_b64 exec, s[40:41]
    buffer_load_dwordx4 v[132:135], v7, s[44:47], s13 offen offset:3072 sc1
    buffer_load_dwordx4 v[136:139], v7, s[44:47], s13 offen offset:3584 sc1
    s_mov_b64 exec, -1
    v_exp_f32 v227, v227
    v_exp_f32 v228, v228
    v_exp_f32 v229, v229
    v_smfmac_f32_32x32x32_bf16 v[236:251], v[100:103], v[220:227], v3
    s_setprio 0
    v_exp_f32 v230, v230
    v_exp_f32 v231, v231
    v_exp_f32 v232, v232
    v_exp_f32 v233, v233
    v_exp_f32 v234, v234
    v_exp_f32 v235, v235
    s_waitcnt vmcnt(9)
    s_setprio 2
    v_exp_f32 v204, v204
    v_exp_f32 v205, v205
    v_exp_f32 v206, v206
    v_exp_f32 v207, v207
    v_smfmac_f32_32x32x32_bf16 v[236:251], v[104:107], v[228:235], v3
    v_exp_f32 v208, v208
    v_exp_f32 v209, v209
    v_exp_f32 v210, v210
    v_mfma_f32_32x32x16_bf16 v[220:235], v[32:35], v[8:11], 0
    buffer_load_dwordx4 v[48:51], v4, s[44:47], s10 offen offset:1024 sc1
    s_mov_b64 exec, s[40:41]
    buffer_load_dwordx4 v[140:143], v7, s[44:47], s14 offen offset:0 sc1
    buffer_load_dwordx4 v[144:147], v7, s[44:47], s14 offen offset:512 sc1
    s_mov_b64 exec, -1
    v_exp_f32 v211, v211
    v_exp_f32 v212, v212
    v_exp_f32 v213, v213
    v_smfmac_f32_32x32x32_bf16 v[236:251], v[108:111], v[204:211], v3
    s_setprio 0
    v_exp_f32 v214, v214
    v_exp_f32 v215, v215
    v_exp_f32 v216, v216
    v_exp_f32 v217, v217
    v_exp_f32 v218, v218
    v_exp_f32 v219, v219
    s_waitcnt vmcnt(9)
    s_setprio 2
    v_exp_f32 v220, v220
    v_exp_f32 v221, v221
    v_exp_f32 v222, v222
    v_exp_f32 v223, v223
    v_smfmac_f32_32x32x32_bf16 v[236:251], v[112:115], v[212:219], v3
    v_exp_f32 v224, v224
    v_exp_f32 v225, v225
    v_exp_f32 v226, v226
    v_mfma_f32_32x32x16_bf16 v[204:219], v[36:39], v[8:11], 0
    buffer_load_dwordx4 v[52:55], v4, s[44:47], s10 offen offset:2048 sc1
    s_mov_b64 exec, s[40:41]
    buffer_load_dwordx4 v[148:151], v7, s[44:47], s14 offen offset:1024 sc1
    buffer_load_dwordx4 v[152:155], v7, s[44:47], s14 offen offset:1536 sc1
    s_mov_b64 exec, -1
    v_exp_f32 v227, v227
    v_exp_f32 v228, v228
    v_exp_f32 v229, v229
    v_smfmac_f32_32x32x32_bf16 v[236:251], v[116:119], v[220:227], v3
    s_setprio 0
    v_exp_f32 v230, v230
    v_exp_f32 v231, v231
    v_exp_f32 v232, v232
    v_exp_f32 v233, v233
    v_exp_f32 v234, v234
    v_exp_f32 v235, v235
    s_waitcnt vmcnt(9)
    s_setprio 2
    v_exp_f32 v204, v204
    v_exp_f32 v205, v205
    v_exp_f32 v206, v206
    v_exp_f32 v207, v207
    v_smfmac_f32_32x32x32_bf16 v[236:251], v[120:123], v[228:235], v3
    v_exp_f32 v208, v208
    v_exp_f32 v209, v209
    v_exp_f32 v210, v210
    v_mfma_f32_32x32x16_bf16 v[220:235], v[40:43], v[8:11], 0
    buffer_load_dwordx4 v[56:59], v4, s[44:47], s10 offen offset:3072 sc1
    s_mov_b64 exec, s[40:41]
    buffer_load_dwordx4 v[156:159], v7, s[44:47], s14 offen offset:2048 sc1
    buffer_load_dwordx4 v[160:163], v7, s[44:47], s14 offen offset:2560 sc1
    s_mov_b64 exec, -1
    v_exp_f32 v211, v211
    v_exp_f32 v212, v212
    v_exp_f32 v213, v213
    v_smfmac_f32_32x32x32_bf16 v[236:251], v[124:127], v[204:211], v3
    s_setprio 0
    v_exp_f32 v214, v214
    v_exp_f32 v215, v215
    v_exp_f32 v216, v216
    v_exp_f32 v217, v217
    v_exp_f32 v218, v218
    v_exp_f32 v219, v219
    s_waitcnt vmcnt(9)
    s_setprio 2
    v_exp_f32 v220, v220
    v_exp_f32 v221, v221
    v_exp_f32 v222, v222
    v_exp_f32 v223, v223
    v_smfmac_f32_32x32x32_bf16 v[236:251], v[128:131], v[212:219], v3
    v_exp_f32 v224, v224
    v_exp_f32 v225, v225
    v_exp_f32 v226, v226
    v_mfma_f32_32x32x16_bf16 v[204:219], v[44:47], v[8:11], 0
    buffer_load_dwordx4 v[60:63], v4, s[44:47], s11 offen offset:0 sc1
    s_mov_b64 exec, s[40:41]
    buffer_load_dwordx4 v[164:167], v7, s[44:47], s14 offen offset:3072 sc1
    buffer_load_dwordx4 v[168:171], v7, s[44:47], s14 offen offset:3584 sc1
    s_mov_b64 exec, -1
    v_exp_f32 v227, v227
    v_exp_f32 v228, v228
    v_exp_f32 v229, v229
    v_smfmac_f32_32x32x32_bf16 v[236:251], v[132:135], v[220:227], v3
    s_setprio 0
    v_exp_f32 v230, v230
    v_exp_f32 v231, v231
    v_exp_f32 v232, v232
    v_exp_f32 v233, v233
    v_exp_f32 v234, v234
    v_exp_f32 v235, v235
    s_waitcnt vmcnt(9)
    s_setprio 2
    v_exp_f32 v204, v204
    v_exp_f32 v205, v205
    v_exp_f32 v206, v206
    v_exp_f32 v207, v207
    v_smfmac_f32_32x32x32_bf16 v[236:251], v[136:139], v[228:235], v3
    v_exp_f32 v208, v208
    v_exp_f32 v209, v209
    v_exp_f32 v210, v210
    v_mfma_f32_32x32x16_bf16 v[220:235], v[48:51], v[8:11], 0
    buffer_load_dwordx4 v[64:67], v4, s[44:47], s11 offen offset:1024 sc1
    s_mov_b64 exec, s[40:41]
    buffer_load_dwordx4 v[172:175], v7, s[44:47], s15 offen offset:0 sc1
    buffer_load_dwordx4 v[176:179], v7, s[44:47], s15 offen offset:512 sc1
    s_mov_b64 exec, -1
    v_exp_f32 v211, v211
    v_exp_f32 v212, v212
    v_exp_f32 v213, v213
    v_smfmac_f32_32x32x32_bf16 v[236:251], v[140:143], v[204:211], v3
    s_setprio 0
    v_exp_f32 v214, v214
    v_exp_f32 v215, v215
    v_exp_f32 v216, v216
    v_exp_f32 v217, v217
    v_exp_f32 v218, v218
    v_exp_f32 v219, v219
    s_waitcnt vmcnt(9)
    s_setprio 2
    v_exp_f32 v220, v220
    v_exp_f32 v221, v221
    v_exp_f32 v222, v222
    v_exp_f32 v223, v223
    v_smfmac_f32_32x32x32_bf16 v[236:251], v[144:147], v[212:219], v3
    v_exp_f32 v224, v224
    v_exp_f32 v225, v225
    v_exp_f32 v226, v226
    v_mfma_f32_32x32x16_bf16 v[204:219], v[52:55], v[8:11], 0
    buffer_load_dwordx4 v[68:71], v4, s[44:47], s11 offen offset:2048 sc1
    s_mov_b64 exec, s[40:41]
    buffer_load_dwordx4 v[180:183], v7, s[44:47], s15 offen offset:1024 sc1
    buffer_load_dwordx4 v[184:187], v7, s[44:47], s15 offen offset:1536 sc1
    s_mov_b64 exec, -1
    v_exp_f32 v227, v227
    v_exp_f32 v228, v228
    v_exp_f32 v229, v229
    v_smfmac_f32_32x32x32_bf16 v[236:251], v[148:151], v[220:227], v3
    s_setprio 0
    v_exp_f32 v230, v230
    v_exp_f32 v231, v231
    v_exp_f32 v232, v232
    v_exp_f32 v233, v233
    v_exp_f32 v234, v234
    v_exp_f32 v235, v235
    s_waitcnt vmcnt(9)
    s_setprio 2
    v_exp_f32 v204, v204
    v_exp_f32 v205, v205
    v_exp_f32 v206, v206
    v_exp_f32 v207, v207
    v_smfmac_f32_32x32x32_bf16 v[236:251], v[152:155], v[228:235], v3
    v_exp_f32 v208, v208
    v_exp_f32 v209, v209
    v_exp_f32 v210, v210
    v_mfma_f32_32x32x16_bf16 v[220:235], v[56:59], v[8:11], 0
    buffer_load_dwordx4 v[72:75], v4, s[44:47], s11 offen offset:3072 sc1
    s_mov_b64 exec, s[40:41]
    buffer_load_dwordx4 v[188:191], v7, s[44:47], s15 offen offset:2048 sc1
    buffer_load_dwordx4 v[192:195], v7, s[44:47], s15 offen offset:2560 sc1
    s_mov_b64 exec, -1
    v_exp_f32 v211, v211
    v_exp_f32 v212, v212
    v_exp_f32 v213, v213
    v_smfmac_f32_32x32x32_bf16 v[236:251], v[156:159], v[204:211], v3
    s_setprio 0
    v_exp_f32 v214, v214
    v_exp_f32 v215, v215
    v_exp_f32 v216, v216
    v_exp_f32 v217, v217
    v_exp_f32 v218, v218
    v_exp_f32 v219, v219
    s_waitcnt vmcnt(9)
    s_setprio 2
    v_exp_f32 v220, v220
    v_exp_f32 v221, v221
    v_exp_f32 v222, v222
    v_exp_f32 v223, v223
    v_smfmac_f32_32x32x32_bf16 v[236:251], v[160:163], v[212:219], v3
    v_exp_f32 v224, v224
    v_exp_f32 v225, v225
    v_exp_f32 v226, v226
    v_mfma_f32_32x32x16_bf16 v[204:219], v[60:63], v[8:11], 0
    s_mov_b64 exec, s[40:41]
    buffer_load_dwordx4 v[196:199], v7, s[44:47], s15 offen offset:3072 sc1
    buffer_load_dwordx4 v[200:203], v7, s[44:47], s15 offen offset:3584 sc1
    s_mov_b64 exec, -1
    v_exp_f32 v227, v227
    v_exp_f32 v228, v228
    v_exp_f32 v229, v229
    v_smfmac_f32_32x32x32_bf16 v[236:251], v[164:167], v[220:227], v3
    s_setprio 0
    v_exp_f32 v230, v230
    v_exp_f32 v231, v231
    v_exp_f32 v232, v232
    v_exp_f32 v233, v233
    v_exp_f32 v234, v234
    v_exp_f32 v235, v235
    s_waitcnt vmcnt(8)
    s_setprio 2
    v_exp_f32 v204, v204
    v_exp_f32 v205, v205
    v_exp_f32 v206, v206
    v_exp_f32 v207, v207
    v_smfmac_f32_32x32x32_bf16 v[236:251], v[168:171], v[228:235], v3
    v_exp_f32 v208, v208
    v_exp_f32 v209, v209
    v_exp_f32 v210, v210
    v_mfma_f32_32x32x16_bf16 v[220:235], v[64:67], v[8:11], 0
    v_mov_b32 v254, 162088
    v_mov_b32 v255, 1
    s_mov_b64 exec, 1
    ds_add_u32 v254, v255
    s_mov_b64 exec, -1
    v_exp_f32 v211, v211
    v_exp_f32 v212, v212
    v_exp_f32 v213, v213
    v_smfmac_f32_32x32x32_bf16 v[236:251], v[172:175], v[204:211], v3
    s_setprio 0
    v_exp_f32 v214, v214
    v_exp_f32 v215, v215
    v_exp_f32 v216, v216
    v_exp_f32 v217, v217
    v_exp_f32 v218, v218
    v_exp_f32 v219, v219
    s_waitcnt vmcnt(5)
    s_setprio 2
    v_exp_f32 v220, v220
    v_exp_f32 v221, v221
    v_exp_f32 v222, v222
    v_exp_f32 v223, v223
    v_smfmac_f32_32x32x32_bf16 v[236:251], v[176:179], v[212:219], v3
    v_exp_f32 v224, v224
    v_exp_f32 v225, v225
    v_exp_f32 v226, v226
    v_mfma_f32_32x32x16_bf16 v[204:219], v[68:71], v[8:11], 0
    v_exp_f32 v227, v227
    v_exp_f32 v228, v228
    v_exp_f32 v229, v229
    v_smfmac_f32_32x32x32_bf16 v[236:251], v[180:183], v[220:227], v3
    s_setprio 0
    v_exp_f32 v230, v230
    v_exp_f32 v231, v231
    v_exp_f32 v232, v232
    v_exp_f32 v233, v233
    v_exp_f32 v234, v234
    v_exp_f32 v235, v235
    s_waitcnt vmcnt(2)
    s_setprio 2
    v_exp_f32 v204, v204
    v_exp_f32 v205, v205
    v_exp_f32 v206, v206
    v_exp_f32 v207, v207
    v_smfmac_f32_32x32x32_bf16 v[236:251], v[184:187], v[228:235], v3
    v_exp_f32 v208, v208
    v_exp_f32 v209, v209
    v_exp_f32 v210, v210
    v_mfma_f32_32x32x16_bf16 v[220:235], v[72:75], v[8:11], 0
    v_add_u32 v2, 1024, v2
    ds_read_b128 v[8:11], v2
    v_exp_f32 v211, v211
    v_exp_f32 v212, v212
    v_exp_f32 v213, v213
    v_smfmac_f32_32x32x32_bf16 v[236:251], v[188:191], v[204:211], v3
    s_setprio 0
    v_exp_f32 v214, v214
    v_exp_f32 v215, v215
    v_exp_f32 v216, v216
    v_exp_f32 v217, v217
    v_exp_f32 v218, v218
    v_exp_f32 v219, v219
    s_waitcnt vmcnt(0)
    s_setprio 2
    v_exp_f32 v220, v220
    v_exp_f32 v221, v221
    v_exp_f32 v222, v222
    v_exp_f32 v223, v223
    v_smfmac_f32_32x32x32_bf16 v[236:251], v[192:195], v[212:219], v3
    v_exp_f32 v224, v224
    v_exp_f32 v225, v225
    v_exp_f32 v226, v226
    s_waitcnt lgkmcnt(0)
    v_mfma_f32_32x32x16_bf16 v[204:219], v[12:15], v[8:11], 0
    v_exp_f32 v227, v227
    v_exp_f32 v228, v228
    v_exp_f32 v229, v229
    v_smfmac_f32_32x32x32_bf16 v[236:251], v[196:199], v[220:227], v3
    s_setprio 0
    v_exp_f32 v230, v230
    v_exp_f32 v231, v231
    v_exp_f32 v232, v232
    v_exp_f32 v233, v233
    v_exp_f32 v234, v234
    v_exp_f32 v235, v235
    s_add_u32 s60, s60, 1
    .p2align 6
A_m_loop:
    s_setprio 2
    v_exp_f32 v204, v204
    v_exp_f32 v205, v205
    v_exp_f32 v206, v206
    v_exp_f32 v207, v207
    v_smfmac_f32_32x32x32_bf16 v[236:251], v[200:203], v[228:235], v3
    v_exp_f32 v208, v208
    v_exp_f32 v209, v209
    v_exp_f32 v210, v210
    v_mfma_f32_32x32x16_bf16 v[220:235], v[16:19], v[8:11], 0
    v_exp_f32 v211, v211
    v_exp_f32 v212, v212
    v_exp_f32 v213, v213
    v_exp_f32 v214, v214
    v_exp_f32 v215, v215
    s_cmp_eq_u32 s60, 0
    s_cbranch_scc1 A_m_nd_5
    ds_write_b128 v0, v[236:239]
    ds_write_b128 v0, v[240:243] offset:1024
    ds_write_b32 v1, v244
    v_exp_f32 v216, v216
    v_mov_b32 v236, 0
    v_mov_b32 v237, 0
    v_mov_b32 v238, 0
    v_mov_b32 v239, 0
    v_mov_b32 v240, 0
    v_mov_b32 v241, 0
    v_mov_b32 v242, 0
    v_mov_b32 v243, 0
    v_mov_b32 v244, 0
    v_add_u32 v0, 2048, v0
    v_add_u32 v1, 128, v1
    s_branch A_m_nd_5_j
A_m_nd_5:
    v_exp_f32 v216, v216
A_m_nd_5_j:
    v_exp_f32 v217, v217
    v_exp_f32 v218, v218
    v_smfmac_f32_32x32x32_bf16 v[236:251], v[76:79], v[204:211], v3
    s_setprio 0
    v_exp_f32 v219, v219
    s_setprio 2
    v_exp_f32 v220, v220
    v_exp_f32 v221, v221
    v_exp_f32 v222, v222
    v_exp_f32 v223, v223
    v_smfmac_f32_32x32x32_bf16 v[236:251], v[80:83], v[212:219], v3
    v_exp_f32 v224, v224
    v_exp_f32 v225, v225
    v_exp_f32 v226, v226
    v_mfma_f32_32x32x16_bf16 v[204:219], v[20:23], v[8:11], 0
    v_exp_f32 v227, v227
    v_exp_f32 v228, v228
    v_exp_f32 v229, v229
    v_smfmac_f32_32x32x32_bf16 v[236:251], v[84:87], v[220:227], v3
    s_setprio 0
    v_exp_f32 v230, v230
    v_exp_f32 v231, v231
    v_exp_f32 v232, v232
    v_exp_f32 v233, v233
    v_exp_f32 v234, v234
    v_exp_f32 v235, v235
    s_setprio 2
    v_exp_f32 v204, v204
    v_exp_f32 v205, v205
    v_exp_f32 v206, v206
    v_exp_f32 v207, v207
    v_smfmac_f32_32x32x32_bf16 v[236:251], v[88:91], v[228:235], v3
    v_exp_f32 v208, v208
    v_exp_f32 v209, v209
    v_exp_f32 v210, v210
    v_mfma_f32_32x32x16_bf16 v[220:235], v[24:27], v[8:11], 0
    v_exp_f32 v211, v211
    v_exp_f32 v212, v212
    v_exp_f32 v213, v213
    v_smfmac_f32_32x32x32_bf16 v[236:251], v[92:95], v[204:211], v3
    s_setprio 0
    v_exp_f32 v214, v214
    v_exp_f32 v215, v215
    v_exp_f32 v216, v216
    v_exp_f32 v217, v217
    v_exp_f32 v218, v218
    v_exp_f32 v219, v219
    s_setprio 2
    v_exp_f32 v220, v220
    v_exp_f32 v221, v221
    v_exp_f32 v222, v222
    v_exp_f32 v223, v223
    v_smfmac_f32_32x32x32_bf16 v[236:251], v[96:99], v[212:219], v3
    v_exp_f32 v224, v224
    v_exp_f32 v225, v225
    v_exp_f32 v226, v226
    v_mfma_f32_32x32x16_bf16 v[204:219], v[28:31], v[8:11], 0
    v_exp_f32 v227, v227
    v_exp_f32 v228, v228
    v_exp_f32 v229, v229
    v_smfmac_f32_32x32x32_bf16 v[236:251], v[100:103], v[220:227], v3
    s_setprio 0
    v_exp_f32 v230, v230
    v_exp_f32 v231, v231
    v_exp_f32 v232, v232
    v_exp_f32 v233, v233
    v_exp_f32 v234, v234
    v_exp_f32 v235, v235
    s_setprio 2
    v_exp_f32 v204, v204
    v_exp_f32 v205, v205
    v_exp_f32 v206, v206
    v_exp_f32 v207, v207
    v_smfmac_f32_32x32x32_bf16 v[236:251], v[104:107], v[228:235], v3
    v_exp_f32 v208, v208
    v_exp_f32 v209, v209
    v_exp_f32 v210, v210
    v_mfma_f32_32x32x16_bf16 v[220:235], v[32:35], v[8:11], 0
    v_exp_f32 v211, v211
    v_exp_f32 v212, v212
    v_exp_f32 v213, v213
    v_smfmac_f32_32x32x32_bf16 v[236:251], v[108:111], v[204:211], v3
    s_setprio 0
    v_exp_f32 v214, v214
    v_exp_f32 v215, v215
    v_exp_f32 v216, v216
    v_exp_f32 v217, v217
    v_exp_f32 v218, v218
    v_exp_f32 v219, v219
    s_setprio 2
    v_exp_f32 v220, v220
    v_exp_f32 v221, v221
    v_exp_f32 v222, v222
    v_exp_f32 v223, v223
    v_smfmac_f32_32x32x32_bf16 v[236:251], v[112:115], v[212:219], v3
    v_exp_f32 v224, v224
    v_exp_f32 v225, v225
    v_exp_f32 v226, v226
    v_mfma_f32_32x32x16_bf16 v[204:219], v[36:39], v[8:11], 0
    v_exp_f32 v227, v227
    v_exp_f32 v228, v228
    v_exp_f32 v229, v229
    v_smfmac_f32_32x32x32_bf16 v[236:251], v[116:119], v[220:227], v3
    s_setprio 0
    v_exp_f32 v230, v230
    v_exp_f32 v231, v231
    v_exp_f32 v232, v232
    v_exp_f32 v233, v233
    v_exp_f32 v234, v234
    v_exp_f32 v235, v235
    s_setprio 2
    v_exp_f32 v204, v204
    v_exp_f32 v205, v205
    v_exp_f32 v206, v206
    v_exp_f32 v207, v207
    v_smfmac_f32_32x32x32_bf16 v[236:251], v[120:123], v[228:235], v3
    v_exp_f32 v208, v208
    v_exp_f32 v209, v209
    v_exp_f32 v210, v210
    v_mfma_f32_32x32x16_bf16 v[220:235], v[40:43], v[8:11], 0
    v_exp_f32 v211, v211
    v_exp_f32 v212, v212
    v_exp_f32 v213, v213
    v_smfmac_f32_32x32x32_bf16 v[236:251], v[124:127], v[204:211], v3
    s_setprio 0
    v_exp_f32 v214, v214
    v_exp_f32 v215, v215
    v_exp_f32 v216, v216
    v_exp_f32 v217, v217
    v_exp_f32 v218, v218
    v_exp_f32 v219, v219
    s_setprio 2
    v_exp_f32 v220, v220
    v_exp_f32 v221, v221
    v_exp_f32 v222, v222
    v_exp_f32 v223, v223
    v_smfmac_f32_32x32x32_bf16 v[236:251], v[128:131], v[212:219], v3
    v_exp_f32 v224, v224
    v_exp_f32 v225, v225
    v_exp_f32 v226, v226
    v_mfma_f32_32x32x16_bf16 v[204:219], v[44:47], v[8:11], 0
    v_exp_f32 v227, v227
    v_exp_f32 v228, v228
    v_exp_f32 v229, v229
    v_smfmac_f32_32x32x32_bf16 v[236:251], v[132:135], v[220:227], v3
    s_setprio 0
    v_exp_f32 v230, v230
    v_exp_f32 v231, v231
    v_exp_f32 v232, v232
    v_exp_f32 v233, v233
    v_exp_f32 v234, v234
    v_exp_f32 v235, v235
    s_setprio 2
    v_exp_f32 v204, v204
    v_exp_f32 v205, v205
    v_exp_f32 v206, v206
    v_exp_f32 v207, v207
    v_smfmac_f32_32x32x32_bf16 v[236:251], v[136:139], v[228:235], v3
    v_exp_f32 v208, v208
    v_exp_f32 v209, v209
    v_exp_f32 v210, v210
    v_mfma_f32_32x32x16_bf16 v[220:235], v[48:51], v[8:11], 0
    v_exp_f32 v211, v211
    v_exp_f32 v212, v212
    v_exp_f32 v213, v213
    v_smfmac_f32_32x32x32_bf16 v[236:251], v[140:143], v[204:211], v3
    s_setprio 0
    v_exp_f32 v214, v214
    v_exp_f32 v215, v215
    v_exp_f32 v216, v216
    v_exp_f32 v217, v217
    v_exp_f32 v218, v218
    v_exp_f32 v219, v219
    s_setprio 2
    v_exp_f32 v220, v220
    v_exp_f32 v221, v221
    v_exp_f32 v222, v222
    v_exp_f32 v223, v223
    v_smfmac_f32_32x32x32_bf16 v[236:251], v[144:147], v[212:219], v3
    v_exp_f32 v224, v224
    v_exp_f32 v225, v225
    v_exp_f32 v226, v226
    v_mfma_f32_32x32x16_bf16 v[204:219], v[52:55], v[8:11], 0
    v_exp_f32 v227, v227
    v_exp_f32 v228, v228
    v_exp_f32 v229, v229
    v_smfmac_f32_32x32x32_bf16 v[236:251], v[148:151], v[220:227], v3
    s_setprio 0
    v_exp_f32 v230, v230
    v_exp_f32 v231, v231
    v_exp_f32 v232, v232
    v_exp_f32 v233, v233
    v_exp_f32 v234, v234
    v_exp_f32 v235, v235
    s_setprio 2
    v_exp_f32 v204, v204
    v_exp_f32 v205, v205
    v_exp_f32 v206, v206
    v_exp_f32 v207, v207
    v_smfmac_f32_32x32x32_bf16 v[236:251], v[152:155], v[228:235], v3
    v_exp_f32 v208, v208
    v_exp_f32 v209, v209
    v_exp_f32 v210, v210
    v_mfma_f32_32x32x16_bf16 v[220:235], v[56:59], v[8:11], 0
    v_exp_f32 v211, v211
    v_exp_f32 v212, v212
    v_exp_f32 v213, v213
    v_smfmac_f32_32x32x32_bf16 v[236:251], v[156:159], v[204:211], v3
    s_setprio 0
    v_exp_f32 v214, v214
    v_exp_f32 v215, v215
    v_exp_f32 v216, v216
    v_exp_f32 v217, v217
    v_exp_f32 v218, v218
    v_exp_f32 v219, v219
    s_setprio 2
    v_exp_f32 v220, v220
    v_exp_f32 v221, v221
    v_exp_f32 v222, v222
    v_exp_f32 v223, v223
    v_smfmac_f32_32x32x32_bf16 v[236:251], v[160:163], v[212:219], v3
    v_exp_f32 v224, v224
    v_exp_f32 v225, v225
    v_exp_f32 v226, v226
    v_mfma_f32_32x32x16_bf16 v[204:219], v[60:63], v[8:11], 0
    v_exp_f32 v227, v227
    v_exp_f32 v228, v228
    v_exp_f32 v229, v229
    v_smfmac_f32_32x32x32_bf16 v[236:251], v[164:167], v[220:227], v3
    s_setprio 0
    v_exp_f32 v230, v230
    v_exp_f32 v231, v231
    v_exp_f32 v232, v232
    v_exp_f32 v233, v233
    v_exp_f32 v234, v234
    v_exp_f32 v235, v235
    s_setprio 2
    v_exp_f32 v204, v204
    v_exp_f32 v205, v205
    v_exp_f32 v206, v206
    v_exp_f32 v207, v207
    v_smfmac_f32_32x32x32_bf16 v[236:251], v[168:171], v[228:235], v3
    v_exp_f32 v208, v208
    v_exp_f32 v209, v209
    v_exp_f32 v210, v210
    v_mfma_f32_32x32x16_bf16 v[220:235], v[64:67], v[8:11], 0
    v_exp_f32 v211, v211
    v_exp_f32 v212, v212
    v_exp_f32 v213, v213
    v_smfmac_f32_32x32x32_bf16 v[236:251], v[172:175], v[204:211], v3
    s_setprio 0
    v_exp_f32 v214, v214
    v_exp_f32 v215, v215
    v_exp_f32 v216, v216
    v_exp_f32 v217, v217
    v_exp_f32 v218, v218
    v_exp_f32 v219, v219
    s_setprio 2
    v_exp_f32 v220, v220
    v_exp_f32 v221, v221
    v_exp_f32 v222, v222
    v_exp_f32 v223, v223
    v_smfmac_f32_32x32x32_bf16 v[236:251], v[176:179], v[212:219], v3
    v_exp_f32 v224, v224
    v_exp_f32 v225, v225
    v_exp_f32 v226, v226
    v_mfma_f32_32x32x16_bf16 v[204:219], v[68:71], v[8:11], 0
    v_exp_f32 v227, v227
    v_exp_f32 v228, v228
    v_exp_f32 v229, v229
    v_smfmac_f32_32x32x32_bf16 v[236:251], v[180:183], v[220:227], v3
    s_setprio 0
    v_exp_f32 v230, v230
    v_exp_f32 v231, v231
    v_exp_f32 v232, v232
    v_exp_f32 v233, v233
    v_exp_f32 v234, v234
    v_exp_f32 v235, v235
    s_setprio 2
    v_exp_f32 v204, v204
    v_exp_f32 v205, v205
    v_exp_f32 v206, v206
    v_exp_f32 v207, v207
    v_smfmac_f32_32x32x32_bf16 v[236:251], v[184:187], v[228:235], v3
    v_exp_f32 v208, v208
    v_exp_f32 v209, v209
    v_exp_f32 v210, v210
    v_mfma_f32_32x32x16_bf16 v[220:235], v[72:75], v[8:11], 0
    v_add_u32 v2, 1024, v2
    ds_read_b128 v[8:11], v2
    v_exp_f32 v211, v211
    v_exp_f32 v212, v212
    v_exp_f32 v213, v213
    v_smfmac_f32_32x32x32_bf16 v[236:251], v[188:191], v[204:211], v3
    s_setprio 0
    v_exp_f32 v214, v214
    v_exp_f32 v215, v215
    v_exp_f32 v216, v216
    v_exp_f32 v217, v217
    v_exp_f32 v218, v218
    v_exp_f32 v219, v219
    s_setprio 2
    v_exp_f32 v220, v220
    v_exp_f32 v221, v221
    v_exp_f32 v222, v222
    v_exp_f32 v223, v223
    v_smfmac_f32_32x32x32_bf16 v[236:251], v[192:195], v[212:219], v3
    v_exp_f32 v224, v224
    v_exp_f32 v225, v225
    v_exp_f32 v226, v226
    s_waitcnt lgkmcnt(0)
    v_mfma_f32_32x32x16_bf16 v[204:219], v[12:15], v[8:11], 0
    v_exp_f32 v227, v227
    v_exp_f32 v228, v228
    v_exp_f32 v229, v229
    v_smfmac_f32_32x32x32_bf16 v[236:251], v[196:199], v[220:227], v3
    s_setprio 0
    v_exp_f32 v230, v230
    v_exp_f32 v231, v231
    v_exp_f32 v232, v232
    v_exp_f32 v233, v233
    v_exp_f32 v234, v234
    v_exp_f32 v235, v235
    s_add_u32 s60, s60, 1
    s_cmp_lg_u32 s60, 8
    s_cbranch_scc1 A_m_loop
A_fin:
    s_setprio 0
    s_nop 1
    v_smfmac_f32_32x32x32_bf16 v[236:251], v[200:203], v[228:235], v3
    s_nop 15
    s_nop 3
    ds_write_b128 v0, v[236:239]
    ds_write_b128 v0, v[240:243] offset:1024
    ds_write_b32 v1, v244
    s_waitcnt lgkmcnt(0)
    v_mov_b32 v252, 162068
    v_mov_b32 v253, 1
    s_mov_b64 exec, 1
    ds_add_u32 v252, v253
    s_mov_b64 exec, -1
    v_mbcnt_lo_u32_b32 v0, -1, 0
    v_mbcnt_hi_u32_b32 v0, -1, v0
    v_lshlrev_b32 v1, 4, v0
    v_and_b32 v2, 31, v0
    v_lshlrev_b32 v2, 2, v2
    s_lshl_b32 s52, s6, 12
    s_add_u32 s52, s52, 81920
    v_add_u32 v4, s52, v1
    s_lshl_b32 s52, s6, 8
    s_add_u32 s52, s52, 155648
    v_add_u32 v5, s52, v2
    v_add_u32 v6, 160768, v2
    s_lshl_b32 s54, s4, 6
    s_lshl_b32 s53, s5, 2
    s_add_u32 s54, s54, s53
    s_add_u32 s54, s54, s6
    s_lshl_b32 s54, s54, 10
    s_add_u32 s54, s54, 12582912
    s_add_u32 s55, s54, 32768
    v_mov_b32 v252, 162068
lw_6:
    ds_read_b32 v253, v252
    s_waitcnt lgkmcnt(0)
    v_readfirstlane_b32 s52, v253
    s_cmp_ge_u32 s52, s59
    s_cbranch_scc1 lw_6_d
    s_sleep 1
    s_add_u32 s58, s58, 1
    s_cmp_lt_u32 s58, 200000
    s_cbranch_scc1 lw_6
lw_6_d:
    ds_read_b128 v[16:19], v4 offset:0
    ds_read_b128 v[20:23], v4 offset:1024
    ds_read_b32 v24, v5 offset:0
    ds_read_b128 v[32:35], v4 offset:16384
    ds_read_b128 v[36:39], v4 offset:17408
    ds_read_b32 v40, v5 offset:1024
    ds_read_b128 v[48:51], v4 offset:32768
    ds_read_b128 v[52:55], v4 offset:33792
    ds_read_b32 v56, v5 offset:2048
    ds_read_b128 v[64:67], v4 offset:49152
    ds_read_b128 v[68:71], v4 offset:50176
    ds_read_b32 v72, v5 offset:3072
    ds_read_b32 v25, v6 offset:0
    ds_read_b128 v[80:83], v4 offset:2048
    ds_read_b128 v[84:87], v4 offset:3072
    ds_read_b32 v88, v5 offset:128
    ds_read_b128 v[96:99], v4 offset:18432
    ds_read_b128 v[100:103], v4 offset:19456
    ds_read_b32 v104, v5 offset:1152
    ds_read_b128 v[112:115], v4 offset:34816
    ds_read_b128 v[116:119], v4 offset:35840
    ds_read_b32 v120, v5 offset:2176
    ds_read_b128 v[128:131], v4 offset:51200
    ds_read_b128 v[132:135], v4 offset:52224
    ds_read_b32 v136, v5 offset:3200
    ds_read_b32 v89, v6 offset:128
    s_waitcnt lgkmcnt(13)
    v_add_f32 v24, v24, v40
    v_add_f32 v56, v56, v72
    v_add_f32 v24, v24, v56
    v_rcp_f32 v24, v24
    v_add_f32 v16, v16, v32
    v_add_f32 v48, v48, v64
    v_add_f32 v17, v17, v33
    v_add_f32 v49, v49, v65
    v_add_f32 v18, v18, v34
    v_add_f32 v50, v50, v66
    v_add_f32 v19, v19, v35
    v_add_f32 v51, v51, v67
    v_add_f32 v20, v20, v36
    v_add_f32 v52, v52, v68
    v_add_f32 v21, v21, v37
    v_add_f32 v53, v53, v69
    v_add_f32 v22, v22, v38
    v_add_f32 v54, v54, v70
    v_add_f32 v23, v23, v39
    v_add_f32 v55, v55, v71
    v_mul_f32 v24, v24, v25
    v_add_f32 v16, v16, v48
    v_add_f32 v17, v17, v49
    v_add_f32 v18, v18, v50
    v_add_f32 v19, v19, v51
    v_add_f32 v20, v20, v52
    v_add_f32 v21, v21, v53
    v_add_f32 v22, v22, v54
    v_add_f32 v23, v23, v55
    v_mul_f32 v16, v24, v16
    v_mul_f32 v17, v24, v17
    v_mul_f32 v18, v24, v18
    v_mul_f32 v19, v24, v19
    v_mul_f32 v20, v24, v20
    v_mul_f32 v21, v24, v21
    v_mul_f32 v22, v24, v22
    v_mul_f32 v23, v24, v23
    v_cvt_pk_bf16_f32 v32, v16, v17
    v_cvt_pk_bf16_f32 v33, v18, v19
    v_cvt_pk_bf16_f32 v34, v20, v21
    v_cvt_pk_bf16_f32 v35, v22, v23
    buffer_store_dwordx4 v[32:35], v1, s[44:47], s54 offen sc1
    s_waitcnt lgkmcnt(0)
    v_mov_b32 v150, 162148
    v_mov_b32 v151, 1
    s_mov_b64 exec, 1
    ds_add_u32 v150, v151
    s_mov_b64 exec, -1
    v_add_f32 v88, v88, v104
    v_add_f32 v120, v120, v136
    v_add_f32 v88, v88, v120
    v_rcp_f32 v88, v88
    v_add_f32 v80, v80, v96
    v_add_f32 v112, v112, v128
    v_add_f32 v81, v81, v97
    v_add_f32 v113, v113, v129
    v_add_f32 v82, v82, v98
    v_add_f32 v114, v114, v130
    v_add_f32 v83, v83, v99
    v_add_f32 v115, v115, v131
    v_add_f32 v84, v84, v100
    v_add_f32 v116, v116, v132
    v_add_f32 v85, v85, v101
    v_add_f32 v117, v117, v133
    v_add_f32 v86, v86, v102
    v_add_f32 v118, v118, v134
    v_add_f32 v87, v87, v103
    v_add_f32 v119, v119, v135
    v_mul_f32 v88, v88, v89
    v_add_f32 v80, v80, v112
    v_add_f32 v81, v81, v113
    v_add_f32 v82, v82, v114
    v_add_f32 v83, v83, v115
    v_add_f32 v84, v84, v116
    v_add_f32 v85, v85, v117
    v_add_f32 v86, v86, v118
    v_add_f32 v87, v87, v119
    v_mul_f32 v80, v88, v80
    v_mul_f32 v81, v88, v81
    v_mul_f32 v82, v88, v82
    v_mul_f32 v83, v88, v83
    v_mul_f32 v84, v88, v84
    v_mul_f32 v85, v88, v85
    v_mul_f32 v86, v88, v86
    v_mul_f32 v87, v88, v87
    v_cvt_pk_bf16_f32 v96, v80, v81
    v_cvt_pk_bf16_f32 v97, v82, v83
    v_cvt_pk_bf16_f32 v98, v84, v85
    v_cvt_pk_bf16_f32 v99, v86, v87
    buffer_store_dwordx4 v[96:99], v1, s[44:47], s55 offen sc1
    s_lshl_b32 s53, s4, 11
    s_lshl_b32 s54, s5, 7
    s_add_u32 s53, s53, s54
    s_add_u32 s53, s53, 2294784
    v_mov_b32 v6, 0
    v_mov_b32 v7, 1
    s_waitcnt vmcnt(0)
    v_mov_b32 v4, 162072
    v_mov_b32 v5, 1
    s_mov_b64 exec, 1
    ds_add_rtn_u32 v5, v4, v5
    s_mov_b64 exec, -1
    s_waitcnt lgkmcnt(0)
    v_readfirstlane_b32 s52, v5
    s_cmp_lg_u32 s52, 3
    s_cbranch_scc1 A_end
    s_mov_b64 exec, 1
    buffer_store_dword v7, v6, s[44:47], s53 offen sc1
    s_mov_b64 exec, -1
A_end:
    s_barrier
    s_waitcnt vmcnt(0) lgkmcnt(0)
    s_endpgm
A_fallback:
    buffer_load_dwordx4 v[32:35], v4, s[44:47], s9 offen offset:1024 sc1
    s_mov_b64 exec, s[40:41]
    buffer_load_dwordx4 v[108:111], v7, s[44:47], s13 offen offset:0 sc1
    buffer_load_dwordx4 v[112:115], v7, s[44:47], s13 offen offset:512 sc1
    s_mov_b64 exec, -1
    buffer_load_dwordx4 v[36:39], v4, s[44:47], s9 offen offset:2048 sc1
    s_mov_b64 exec, s[40:41]
    buffer_load_dwordx4 v[116:119], v7, s[44:47], s13 offen offset:1024 sc1
    buffer_load_dwordx4 v[120:123], v7, s[44:47], s13 offen offset:1536 sc1
    s_mov_b64 exec, -1
    buffer_load_dwordx4 v[40:43], v4, s[44:47], s9 offen offset:3072 sc1
    s_mov_b64 exec, s[40:41]
    buffer_load_dwordx4 v[124:127], v7, s[44:47], s13 offen offset:2048 sc1
    buffer_load_dwordx4 v[128:131], v7, s[44:47], s13 offen offset:2560 sc1
    s_mov_b64 exec, -1
    buffer_load_dwordx4 v[44:47], v4, s[44:47], s10 offen offset:0 sc1
    s_mov_b64 exec, s[40:41]
    buffer_load_dwordx4 v[132:135], v7, s[44:47], s13 offen offset:3072 sc1
    buffer_load_dwordx4 v[136:139], v7, s[44:47], s13 offen offset:3584 sc1
    s_mov_b64 exec, -1
    buffer_load_dwordx4 v[48:51], v4, s[44:47], s10 offen offset:1024 sc1
    s_mov_b64 exec, s[40:41]
    buffer_load_dwordx4 v[140:143], v7, s[44:47], s14 offen offset:0 sc1
    buffer_load_dwordx4 v[144:147], v7, s[44:47], s14 offen offset:512 sc1
    s_mov_b64 exec, -1
    buffer_load_dwordx4 v[52:55], v4, s[44:47], s10 offen offset:2048 sc1
    s_mov_b64 exec, s[40:41]
    buffer_load_dwordx4 v[148:151], v7, s[44:47], s14 offen offset:1024 sc1
    buffer_load_dwordx4 v[152:155], v7, s[44:47], s14 offen offset:1536 sc1
    s_mov_b64 exec, -1
    buffer_load_dwordx4 v[56:59], v4, s[44:47], s10 offen offset:3072 sc1
    s_mov_b64 exec, s[40:41]
    buffer_load_dwordx4 v[156:159], v7, s[44:47], s14 offen offset:2048 sc1
    buffer_load_dwordx4 v[160:163], v7, s[44:47], s14 offen offset:2560 sc1
    s_mov_b64 exec, -1
    buffer_load_dwordx4 v[60:63], v4, s[44:47], s11 offen offset:0 sc1
    s_mov_b64 exec, s[40:41]
    buffer_load_dwordx4 v[164:167], v7, s[44:47], s14 offen offset:3072 sc1
    buffer_load_dwordx4 v[168:171], v7, s[44:47], s14 offen offset:3584 sc1
    s_mov_b64 exec, -1
    buffer_load_dwordx4 v[64:67], v4, s[44:47], s11 offen offset:1024 sc1
    s_mov_b64 exec, s[40:41]
    buffer_load_dwordx4 v[172:175], v7, s[44:47], s15 offen offset:0 sc1
    buffer_load_dwordx4 v[176:179], v7, s[44:47], s15 offen offset:512 sc1
    s_mov_b64 exec, -1
    buffer_load_dwordx4 v[68:71], v4, s[44:47], s11 offen offset:2048 sc1
    s_mov_b64 exec, s[40:41]
    buffer_load_dwordx4 v[180:183], v7, s[44:47], s15 offen offset:1024 sc1
    buffer_load_dwordx4 v[184:187], v7, s[44:47], s15 offen offset:1536 sc1
    s_mov_b64 exec, -1
    buffer_load_dwordx4 v[72:75], v4, s[44:47], s11 offen offset:3072 sc1
    s_mov_b64 exec, s[40:41]
    buffer_load_dwordx4 v[188:191], v7, s[44:47], s15 offen offset:2048 sc1
    buffer_load_dwordx4 v[192:195], v7, s[44:47], s15 offen offset:2560 sc1
    s_mov_b64 exec, -1
    s_mov_b64 exec, s[40:41]
    buffer_load_dwordx4 v[196:199], v7, s[44:47], s15 offen offset:3072 sc1
    buffer_load_dwordx4 v[200:203], v7, s[44:47], s15 offen offset:3584 sc1
    s_mov_b64 exec, -1
    s_waitcnt vmcnt(0)
    v_mov_b32 v254, 162088
    v_mov_b32 v255, 1
    s_mov_b64 exec, 1
    ds_add_u32 v254, v255
    s_mov_b64 exec, -1
A_fb1:
    v_mov_b32 v4, 0xff800000
    v_mfma_f32_32x32x16_bf16 v[204:219], v[12:15], v[8:11], 0
    v_mfma_f32_32x32x16_bf16 v[220:235], v[16:19], v[8:11], 0
    s_nop 7
    v_max3_f32 v4, v204, v205, v4
    v_max3_f32 v4, v206, v207, v4
    v_max3_f32 v4, v208, v209, v4
    v_max3_f32 v4, v210, v211, v4
    v_max3_f32 v4, v212, v213, v4
    v_max3_f32 v4, v214, v215, v4
    v_max3_f32 v4, v216, v217, v4
    v_max3_f32 v4, v218, v219, v4
    v_mfma_f32_32x32x16_bf16 v[204:219], v[20:23], v[8:11], 0
    s_nop 7
    v_max3_f32 v4, v220, v221, v4
    v_max3_f32 v4, v222, v223, v4
    v_max3_f32 v4, v224, v225, v4
    v_max3_f32 v4, v226, v227, v4
    v_max3_f32 v4, v228, v229, v4
    v_max3_f32 v4, v230, v231, v4
    v_max3_f32 v4, v232, v233, v4
    v_max3_f32 v4, v234, v235, v4
    v_mfma_f32_32x32x16_bf16 v[220:235], v[24:27], v[8:11], 0
    s_nop 7
    v_max3_f32 v4, v204, v205, v4
    v_max3_f32 v4, v206, v207, v4
    v_max3_f32 v4, v208, v209, v4
    v_max3_f32 v4, v210, v211, v4
    v_max3_f32 v4, v212, v213, v4
    v_max3_f32 v4, v214, v215, v4
    v_max3_f32 v4, v216, v217, v4
    v_max3_f32 v4, v218, v219, v4
    v_mfma_f32_32x32x16_bf16 v[204:219], v[28:31], v[8:11], 0
    s_nop 7
    v_max3_f32 v4, v220, v221, v4
    v_max3_f32 v4, v222, v223, v4
    v_max3_f32 v4, v224, v225, v4
    v_max3_f32 v4, v226, v227, v4
    v_max3_f32 v4, v228, v229, v4
    v_max3_f32 v4, v230, v231, v4
    v_max3_f32 v4, v232, v233, v4
    v_max3_f32 v4, v234, v235, v4
    v_mfma_f32_32x32x16_bf16 v[220:235], v[32:35], v[8:11], 0
    s_nop 7
    v_max3_f32 v4, v204, v205, v4
    v_max3_f32 v4, v206, v207, v4
    v_max3_f32 v4, v208, v209, v4
    v_max3_f32 v4, v210, v211, v4
    v_max3_f32 v4, v212, v213, v4
    v_max3_f32 v4, v214, v215, v4
    v_max3_f32 v4, v216, v217, v4
    v_max3_f32 v4, v218, v219, v4
    v_mfma_f32_32x32x16_bf16 v[204:219], v[36:39], v[8:11], 0
    s_nop 7
    v_max3_f32 v4, v220, v221, v4
    v_max3_f32 v4, v222, v223, v4
    v_max3_f32 v4, v224, v225, v4
    v_max3_f32 v4, v226, v227, v4
    v_max3_f32 v4, v228, v229, v4
    v_max3_f32 v4, v230, v231, v4
    v_max3_f32 v4, v232, v233, v4
    v_max3_f32 v4, v234, v235, v4
    v_mfma_f32_32x32x16_bf16 v[220:235], v[40:43], v[8:11], 0
    s_nop 7
    v_max3_f32 v4, v204, v205, v4
    v_max3_f32 v4, v206, v207, v4
    v_max3_f32 v4, v208, v209, v4
    v_max3_f32 v4, v210, v211, v4
    v_max3_f32 v4, v212, v213, v4
    v_max3_f32 v4, v214, v215, v4
    v_max3_f32 v4, v216, v217, v4
    v_max3_f32 v4, v218, v219, v4
    v_mfma_f32_32x32x16_bf16 v[204:219], v[44:47], v[8:11], 0
    s_nop 7
    v_max3_f32 v4, v220, v221, v4
    v_max3_f32 v4, v222, v223, v4
    v_max3_f32 v4, v224, v225, v4
    v_max3_f32 v4, v226, v227, v4
    v_max3_f32 v4, v228, v229, v4
    v_max3_f32 v4, v230, v231, v4
    v_max3_f32 v4, v232, v233, v4
    v_max3_f32 v4, v234, v235, v4
    v_mfma_f32_32x32x16_bf16 v[220:235], v[48:51], v[8:11], 0
    s_nop 7
    v_max3_f32 v4, v204, v205, v4
    v_max3_f32 v4, v206, v207, v4
    v_max3_f32 v4, v208, v209, v4
    v_max3_f32 v4, v210, v211, v4
    v_max3_f32 v4, v212, v213, v4
    v_max3_f32 v4, v214, v215, v4
    v_max3_f32 v4, v216, v217, v4
    v_max3_f32 v4, v218, v219, v4
    v_mfma_f32_32x32x16_bf16 v[204:219], v[52:55], v[8:11], 0
    s_nop 7
    v_max3_f32 v4, v220, v221, v4
    v_max3_f32 v4, v222, v223, v4
    v_max3_f32 v4, v224, v225, v4
    v_max3_f32 v4, v226, v227, v4
    v_max3_f32 v4, v228, v229, v4
    v_max3_f32 v4, v230, v231, v4
    v_max3_f32 v4, v232, v233, v4
    v_max3_f32 v4, v234, v235, v4
    v_mfma_f32_32x32x16_bf16 v[220:235], v[56:59], v[8:11], 0
    s_nop 7
    v_max3_f32 v4, v204, v205, v4
    v_max3_f32 v4, v206, v207, v4
    v_max3_f32 v4, v208, v209, v4
    v_max3_f32 v4, v210, v211, v4
    v_max3_f32 v4, v212, v213, v4
    v_max3_f32 v4, v214, v215, v4
    v_max3_f32 v4, v216, v217, v4
    v_max3_f32 v4, v218, v219, v4
    v_mfma_f32_32x32x16_bf16 v[204:219], v[60:63], v[8:11], 0
    s_nop 7
    v_max3_f32 v4, v220, v221, v4
    v_max3_f32 v4, v222, v223, v4
    v_max3_f32 v4, v224, v225, v4
    v_max3_f32 v4, v226, v227, v4
    v_max3_f32 v4, v228, v229, v4
    v_max3_f32 v4, v230, v231, v4
    v_max3_f32 v4, v232, v233, v4
    v_max3_f32 v4, v234, v235, v4
    v_mfma_f32_32x32x16_bf16 v[220:235], v[64:67], v[8:11], 0
    s_nop 7
    v_max3_f32 v4, v204, v205, v4
    v_max3_f32 v4, v206, v207, v4
    v_max3_f32 v4, v208, v209, v4
    v_max3_f32 v4, v210, v211, v4
    v_max3_f32 v4, v212, v213, v4
    v_max3_f32 v4, v214, v215, v4
    v_max3_f32 v4, v216, v217, v4
    v_max3_f32 v4, v218, v219, v4
    v_mfma_f32_32x32x16_bf16 v[204:219], v[68:71], v[8:11], 0
    s_nop 7
    v_max3_f32 v4, v220, v221, v4
    v_max3_f32 v4, v222, v223, v4
    v_max3_f32 v4, v224, v225, v4
    v_max3_f32 v4, v226, v227, v4
    v_max3_f32 v4, v228, v229, v4
    v_max3_f32 v4, v230, v231, v4
    v_max3_f32 v4, v232, v233, v4
    v_max3_f32 v4, v234, v235, v4
    v_mfma_f32_32x32x16_bf16 v[220:235], v[72:75], v[8:11], 0
    s_nop 7
    v_max3_f32 v4, v204, v205, v4
    v_max3_f32 v4, v206, v207, v4
    v_max3_f32 v4, v208, v209, v4
    v_max3_f32 v4, v210, v211, v4
    v_max3_f32 v4, v212, v213, v4
    v_max3_f32 v4, v214, v215, v4
    v_max3_f32 v4, v216, v217, v4
    v_max3_f32 v4, v218, v219, v4
    v_add_u32 v2, 1024, v2
    s_nop 15
    ds_read_b128 v[8:11], v2
    v_max3_f32 v4, v220, v221, v4
    v_max3_f32 v4, v222, v223, v4
    v_max3_f32 v4, v224, v225, v4
    v_max3_f32 v4, v226, v227, v4
    v_max3_f32 v4, v228, v229, v4
    v_max3_f32 v4, v230, v231, v4
    v_max3_f32 v4, v232, v233, v4
    v_max3_f32 v4, v234, v235, v4
    v_mov_b32 v7, v4
    s_nop 1
    v_permlane32_swap_b32 v4, v7
    s_nop 1
    v_max_f32 v4, v4, v7
    ds_max_f32 v6, v4
    v_add_u32 v6, 128, v6
    s_add_u32 s60, s60, 1
    s_waitcnt lgkmcnt(0)
    s_cmp_lg_u32 s60, 8
    s_cbranch_scc1 A_fb1
    v_mov_b32 v252, 162080
    v_mov_b32 v253, 1
    s_mov_b64 exec, 1
    ds_add_u32 v252, v253
    s_mov_b64 exec, -1
    v_mov_b32 v252, 162080
lw_7:
    ds_read_b32 v253, v252
    s_waitcnt lgkmcnt(0)
    v_readfirstlane_b32 s52, v253
    s_cmp_ge_u32 s52, 4
    s_cbranch_scc1 lw_7_d
    s_sleep 1
    s_add_u32 s58, s58, 1
    s_cmp_lt_u32 s58, 200000
    s_cbranch_scc1 lw_7
lw_7_d:
    s_mov_b32 s59, 4
    v_mbcnt_lo_u32_b32 v252, -1, 0
    v_mbcnt_hi_u32_b32 v252, -1, v252
    v_lshlrev_b32 v253, 4, v252
    s_lshl_b32 s52, s6, 14
    s_add_u32 s52, s52, 81920
    v_add_u32 v0, s52, v253
    v_add_u32 v2, 147456, v253
    v_and_b32 v6, 31, v252
    v_lshlrev_b32 v6, 2, v6
    s_lshl_b32 s52, s6, 10
    s_add_u32 s52, s52, 155648
    v_add_u32 v1, s52, v6
    v_add_u32 v6, 159744, v6
    v_mov_b64 v[236:237], 0
    v_mov_b64 v[238:239], 0
    v_mov_b64 v[240:241], 0
    v_mov_b64 v[242:243], 0
    v_mov_b64 v[244:245], 0
    v_mov_b64 v[246:247], 0
    v_mov_b64 v[248:249], 0
    v_mov_b64 v[250:251], 0
    v_mov_b64 v[228:229], 0
    v_mov_b64 v[230:231], 0
    v_mov_b64 v[232:233], 0
    v_mov_b64 v[234:235], 0
    s_mov_b32 s60, 0
    ds_read_b128 v[8:11], v2
    ds_read_b32 v4, v6
    s_waitcnt lgkmcnt(0)
    v_mfma_f32_32x32x16_bf16 v[204:219], v[12:15], v[8:11], 0
    s_nop 15
    s_nop 3
    .p2align 6
A_f_loop:
    s_setprio 2
    v_sub_f32 v204, v204, v4
    v_exp_f32 v204, v204
    v_sub_f32 v205, v205, v4
    v_exp_f32 v205, v205
    v_sub_f32 v206, v206, v4
    v_exp_f32 v206, v206
    v_sub_f32 v207, v207, v4
    v_exp_f32 v207, v207
    v_smfmac_f32_32x32x32_bf16 v[236:251], v[200:203], v[228:235], v3
    v_sub_f32 v208, v208, v4
    v_exp_f32 v208, v208
    v_sub_f32 v209, v209, v4
    v_exp_f32 v209, v209
    v_sub_f32 v210, v210, v4
    v_exp_f32 v210, v210
    v_mfma_f32_32x32x16_bf16 v[220:235], v[16:19], v[8:11], 0
    v_sub_f32 v211, v211, v4
    v_exp_f32 v211, v211
    v_sub_f32 v212, v212, v4
    v_exp_f32 v212, v212
    v_sub_f32 v213, v213, v4
    v_exp_f32 v213, v213
    v_sub_f32 v214, v214, v4
    v_exp_f32 v214, v214
    v_sub_f32 v215, v215, v4
    v_exp_f32 v215, v215
    s_cmp_eq_u32 s60, 0
    s_cbranch_scc1 A_f_nd_8
    ds_write_b128 v0, v[236:239]
    ds_write_b128 v0, v[240:243] offset:1024
    ds_write_b32 v1, v244
    v_sub_f32 v216, v216, v4
    v_exp_f32 v216, v216
    v_mov_b32 v236, 0
    v_mov_b32 v237, 0
    v_mov_b32 v238, 0
    v_mov_b32 v239, 0
    v_mov_b32 v240, 0
    v_mov_b32 v241, 0
    v_mov_b32 v242, 0
    v_mov_b32 v243, 0
    v_mov_b32 v244, 0
    v_add_u32 v0, 2048, v0
    v_add_u32 v1, 128, v1
    s_branch A_f_nd_8_j
A_f_nd_8:
    v_sub_f32 v216, v216, v4
    v_exp_f32 v216, v216
A_f_nd_8_j:
    v_sub_f32 v217, v217, v4
    v_exp_f32 v217, v217
    v_sub_f32 v218, v218, v4
    v_exp_f32 v218, v218
    v_smfmac_f32_32x32x32_bf16 v[236:251], v[76:79], v[204:211], v3
    s_setprio 0
    v_sub_f32 v219, v219, v4
    v_exp_f32 v219, v219
    s_setprio 2
    v_sub_f32 v220, v220, v4
    v_exp_f32 v220, v220
    v_sub_f32 v221, v221, v4
    v_exp_f32 v221, v221
    v_sub_f32 v222, v222, v4
    v_exp_f32 v222, v222
    v_sub_f32 v223, v223, v4
    v_exp_f32 v223, v223
    v_smfmac_f32_32x32x32_bf16 v[236:251], v[80:83], v[212:219], v3
    v_sub_f32 v224, v224, v4
    v_exp_f32 v224, v224
    v_sub_f32 v225, v225, v4
    v_exp_f32 v225, v225
    v_sub_f32 v226, v226, v4
    v_exp_f32 v226, v226
    v_mfma_f32_32x32x16_bf16 v[204:219], v[20:23], v[8:11], 0
    v_sub_f32 v227, v227, v4
    v_exp_f32 v227, v227
    v_sub_f32 v228, v228, v4
    v_exp_f32 v228, v228
    v_sub_f32 v229, v229, v4
    v_exp_f32 v229, v229
    v_smfmac_f32_32x32x32_bf16 v[236:251], v[84:87], v[220:227], v3
    s_setprio 0
    v_sub_f32 v230, v230, v4
    v_exp_f32 v230, v230
    v_sub_f32 v231, v231, v4
    v_exp_f32 v231, v231
    v_sub_f32 v232, v232, v4
    v_exp_f32 v232, v232
    v_sub_f32 v233, v233, v4
    v_exp_f32 v233, v233
    v_sub_f32 v234, v234, v4
    v_exp_f32 v234, v234
    v_sub_f32 v235, v235, v4
    v_exp_f32 v235, v235
    s_setprio 2
    v_sub_f32 v204, v204, v4
    v_exp_f32 v204, v204
    v_sub_f32 v205, v205, v4
    v_exp_f32 v205, v205
    v_sub_f32 v206, v206, v4
    v_exp_f32 v206, v206
    v_sub_f32 v207, v207, v4
    v_exp_f32 v207, v207
    v_smfmac_f32_32x32x32_bf16 v[236:251], v[88:91], v[228:235], v3
    v_sub_f32 v208, v208, v4
    v_exp_f32 v208, v208
    v_sub_f32 v209, v209, v4
    v_exp_f32 v209, v209
    v_sub_f32 v210, v210, v4
    v_exp_f32 v210, v210
    v_mfma_f32_32x32x16_bf16 v[220:235], v[24:27], v[8:11], 0
    v_sub_f32 v211, v211, v4
    v_exp_f32 v211, v211
    v_sub_f32 v212, v212, v4
    v_exp_f32 v212, v212
    v_sub_f32 v213, v213, v4
    v_exp_f32 v213, v213
    v_smfmac_f32_32x32x32_bf16 v[236:251], v[92:95], v[204:211], v3
    s_setprio 0
    v_sub_f32 v214, v214, v4
    v_exp_f32 v214, v214
    v_sub_f32 v215, v215, v4
    v_exp_f32 v215, v215
    v_sub_f32 v216, v216, v4
    v_exp_f32 v216, v216
    v_sub_f32 v217, v217, v4
    v_exp_f32 v217, v217
    v_sub_f32 v218, v218, v4
    v_exp_f32 v218, v218
    v_sub_f32 v219, v219, v4
    v_exp_f32 v219, v219
    s_setprio 2
    v_sub_f32 v220, v220, v4
    v_exp_f32 v220, v220
    v_sub_f32 v221, v221, v4
    v_exp_f32 v221, v221
    v_sub_f32 v222, v222, v4
    v_exp_f32 v222, v222
    v_sub_f32 v223, v223, v4
    v_exp_f32 v223, v223
    v_smfmac_f32_32x32x32_bf16 v[236:251], v[96:99], v[212:219], v3
    v_sub_f32 v224, v224, v4
    v_exp_f32 v224, v224
    v_sub_f32 v225, v225, v4
    v_exp_f32 v225, v225
    v_sub_f32 v226, v226, v4
    v_exp_f32 v226, v226
    v_mfma_f32_32x32x16_bf16 v[204:219], v[28:31], v[8:11], 0
    v_sub_f32 v227, v227, v4
    v_exp_f32 v227, v227
    v_sub_f32 v228, v228, v4
    v_exp_f32 v228, v228
    v_sub_f32 v229, v229, v4
    v_exp_f32 v229, v229
    v_smfmac_f32_32x32x32_bf16 v[236:251], v[100:103], v[220:227], v3
    s_setprio 0
    v_sub_f32 v230, v230, v4
    v_exp_f32 v230, v230
    v_sub_f32 v231, v231, v4
    v_exp_f32 v231, v231
    v_sub_f32 v232, v232, v4
    v_exp_f32 v232, v232
    v_sub_f32 v233, v233, v4
    v_exp_f32 v233, v233
    v_sub_f32 v234, v234, v4
    v_exp_f32 v234, v234
    v_sub_f32 v235, v235, v4
    v_exp_f32 v235, v235
    s_setprio 2
    v_sub_f32 v204, v204, v4
    v_exp_f32 v204, v204
    v_sub_f32 v205, v205, v4
    v_exp_f32 v205, v205
    v_sub_f32 v206, v206, v4
    v_exp_f32 v206, v206
    v_sub_f32 v207, v207, v4
    v_exp_f32 v207, v207
    v_smfmac_f32_32x32x32_bf16 v[236:251], v[104:107], v[228:235], v3
    v_sub_f32 v208, v208, v4
    v_exp_f32 v208, v208
    v_sub_f32 v209, v209, v4
    v_exp_f32 v209, v209
    v_sub_f32 v210, v210, v4
    v_exp_f32 v210, v210
    v_mfma_f32_32x32x16_bf16 v[220:235], v[32:35], v[8:11], 0
    v_sub_f32 v211, v211, v4
    v_exp_f32 v211, v211
    v_sub_f32 v212, v212, v4
    v_exp_f32 v212, v212
    v_sub_f32 v213, v213, v4
    v_exp_f32 v213, v213
    v_smfmac_f32_32x32x32_bf16 v[236:251], v[108:111], v[204:211], v3
    s_setprio 0
    v_sub_f32 v214, v214, v4
    v_exp_f32 v214, v214
    v_sub_f32 v215, v215, v4
    v_exp_f32 v215, v215
    v_sub_f32 v216, v216, v4
    v_exp_f32 v216, v216
    v_sub_f32 v217, v217, v4
    v_exp_f32 v217, v217
    v_sub_f32 v218, v218, v4
    v_exp_f32 v218, v218
    v_sub_f32 v219, v219, v4
    v_exp_f32 v219, v219
    s_setprio 2
    v_sub_f32 v220, v220, v4
    v_exp_f32 v220, v220
    v_sub_f32 v221, v221, v4
    v_exp_f32 v221, v221
    v_sub_f32 v222, v222, v4
    v_exp_f32 v222, v222
    v_sub_f32 v223, v223, v4
    v_exp_f32 v223, v223
    v_smfmac_f32_32x32x32_bf16 v[236:251], v[112:115], v[212:219], v3
    v_sub_f32 v224, v224, v4
    v_exp_f32 v224, v224
    v_sub_f32 v225, v225, v4
    v_exp_f32 v225, v225
    v_sub_f32 v226, v226, v4
    v_exp_f32 v226, v226
    v_mfma_f32_32x32x16_bf16 v[204:219], v[36:39], v[8:11], 0
    v_sub_f32 v227, v227, v4
    v_exp_f32 v227, v227
    v_sub_f32 v228, v228, v4
    v_exp_f32 v228, v228
    v_sub_f32 v229, v229, v4
    v_exp_f32 v229, v229
    v_smfmac_f32_32x32x32_bf16 v[236:251], v[116:119], v[220:227], v3
    s_setprio 0
    v_sub_f32 v230, v230, v4
    v_exp_f32 v230, v230
    v_sub_f32 v231, v231, v4
    v_exp_f32 v231, v231
    v_sub_f32 v232, v232, v4
    v_exp_f32 v232, v232
    v_sub_f32 v233, v233, v4
    v_exp_f32 v233, v233
    v_sub_f32 v234, v234, v4
    v_exp_f32 v234, v234
    v_sub_f32 v235, v235, v4
    v_exp_f32 v235, v235
    s_setprio 2
    v_sub_f32 v204, v204, v4
    v_exp_f32 v204, v204
    v_sub_f32 v205, v205, v4
    v_exp_f32 v205, v205
    v_sub_f32 v206, v206, v4
    v_exp_f32 v206, v206
    v_sub_f32 v207, v207, v4
    v_exp_f32 v207, v207
    v_smfmac_f32_32x32x32_bf16 v[236:251], v[120:123], v[228:235], v3
    v_sub_f32 v208, v208, v4
    v_exp_f32 v208, v208
    v_sub_f32 v209, v209, v4
    v_exp_f32 v209, v209
    v_sub_f32 v210, v210, v4
    v_exp_f32 v210, v210
    v_mfma_f32_32x32x16_bf16 v[220:235], v[40:43], v[8:11], 0
    v_sub_f32 v211, v211, v4
    v_exp_f32 v211, v211
    v_sub_f32 v212, v212, v4
    v_exp_f32 v212, v212
    v_sub_f32 v213, v213, v4
    v_exp_f32 v213, v213
    v_smfmac_f32_32x32x32_bf16 v[236:251], v[124:127], v[204:211], v3
    s_setprio 0
    v_sub_f32 v214, v214, v4
    v_exp_f32 v214, v214
    v_sub_f32 v215, v215, v4
    v_exp_f32 v215, v215
    v_sub_f32 v216, v216, v4
    v_exp_f32 v216, v216
    v_sub_f32 v217, v217, v4
    v_exp_f32 v217, v217
    v_sub_f32 v218, v218, v4
    v_exp_f32 v218, v218
    v_sub_f32 v219, v219, v4
    v_exp_f32 v219, v219
    s_setprio 2
    v_sub_f32 v220, v220, v4
    v_exp_f32 v220, v220
    v_sub_f32 v221, v221, v4
    v_exp_f32 v221, v221
    v_sub_f32 v222, v222, v4
    v_exp_f32 v222, v222
    v_sub_f32 v223, v223, v4
    v_exp_f32 v223, v223
    v_smfmac_f32_32x32x32_bf16 v[236:251], v[128:131], v[212:219], v3
    v_sub_f32 v224, v224, v4
    v_exp_f32 v224, v224
    v_sub_f32 v225, v225, v4
    v_exp_f32 v225, v225
    v_sub_f32 v226, v226, v4
    v_exp_f32 v226, v226
    v_mfma_f32_32x32x16_bf16 v[204:219], v[44:47], v[8:11], 0
    v_sub_f32 v227, v227, v4
    v_exp_f32 v227, v227
    v_sub_f32 v228, v228, v4
    v_exp_f32 v228, v228
    v_sub_f32 v229, v229, v4
    v_exp_f32 v229, v229
    v_smfmac_f32_32x32x32_bf16 v[236:251], v[132:135], v[220:227], v3
    s_setprio 0
    v_sub_f32 v230, v230, v4
    v_exp_f32 v230, v230
    v_sub_f32 v231, v231, v4
    v_exp_f32 v231, v231
    v_sub_f32 v232, v232, v4
    v_exp_f32 v232, v232
    v_sub_f32 v233, v233, v4
    v_exp_f32 v233, v233
    v_sub_f32 v234, v234, v4
    v_exp_f32 v234, v234
    v_sub_f32 v235, v235, v4
    v_exp_f32 v235, v235
    s_setprio 2
    v_sub_f32 v204, v204, v4
    v_exp_f32 v204, v204
    v_sub_f32 v205, v205, v4
    v_exp_f32 v205, v205
    v_sub_f32 v206, v206, v4
    v_exp_f32 v206, v206
    v_sub_f32 v207, v207, v4
    v_exp_f32 v207, v207
    v_smfmac_f32_32x32x32_bf16 v[236:251], v[136:139], v[228:235], v3
    v_sub_f32 v208, v208, v4
    v_exp_f32 v208, v208
    v_sub_f32 v209, v209, v4
    v_exp_f32 v209, v209
    v_sub_f32 v210, v210, v4
    v_exp_f32 v210, v210
    v_mfma_f32_32x32x16_bf16 v[220:235], v[48:51], v[8:11], 0
    v_sub_f32 v211, v211, v4
    v_exp_f32 v211, v211
    v_sub_f32 v212, v212, v4
    v_exp_f32 v212, v212
    v_sub_f32 v213, v213, v4
    v_exp_f32 v213, v213
    v_smfmac_f32_32x32x32_bf16 v[236:251], v[140:143], v[204:211], v3
    s_setprio 0
    v_sub_f32 v214, v214, v4
    v_exp_f32 v214, v214
    v_sub_f32 v215, v215, v4
    v_exp_f32 v215, v215
    v_sub_f32 v216, v216, v4
    v_exp_f32 v216, v216
    v_sub_f32 v217, v217, v4
    v_exp_f32 v217, v217
    v_sub_f32 v218, v218, v4
    v_exp_f32 v218, v218
    v_sub_f32 v219, v219, v4
    v_exp_f32 v219, v219
    s_setprio 2
    v_sub_f32 v220, v220, v4
    v_exp_f32 v220, v220
    v_sub_f32 v221, v221, v4
    v_exp_f32 v221, v221
    v_sub_f32 v222, v222, v4
    v_exp_f32 v222, v222
    v_sub_f32 v223, v223, v4
    v_exp_f32 v223, v223
    v_smfmac_f32_32x32x32_bf16 v[236:251], v[144:147], v[212:219], v3
    v_sub_f32 v224, v224, v4
    v_exp_f32 v224, v224
    v_sub_f32 v225, v225, v4
    v_exp_f32 v225, v225
    v_sub_f32 v226, v226, v4
    v_exp_f32 v226, v226
    v_mfma_f32_32x32x16_bf16 v[204:219], v[52:55], v[8:11], 0
    v_sub_f32 v227, v227, v4
    v_exp_f32 v227, v227
    v_sub_f32 v228, v228, v4
    v_exp_f32 v228, v228
    v_sub_f32 v229, v229, v4
    v_exp_f32 v229, v229
    v_smfmac_f32_32x32x32_bf16 v[236:251], v[148:151], v[220:227], v3
    s_setprio 0
    v_sub_f32 v230, v230, v4
    v_exp_f32 v230, v230
    v_sub_f32 v231, v231, v4
    v_exp_f32 v231, v231
    v_sub_f32 v232, v232, v4
    v_exp_f32 v232, v232
    v_sub_f32 v233, v233, v4
    v_exp_f32 v233, v233
    v_sub_f32 v234, v234, v4
    v_exp_f32 v234, v234
    v_sub_f32 v235, v235, v4
    v_exp_f32 v235, v235
    s_setprio 2
    v_sub_f32 v204, v204, v4
    v_exp_f32 v204, v204
    v_sub_f32 v205, v205, v4
    v_exp_f32 v205, v205
    v_sub_f32 v206, v206, v4
    v_exp_f32 v206, v206
    v_sub_f32 v207, v207, v4
    v_exp_f32 v207, v207
    v_smfmac_f32_32x32x32_bf16 v[236:251], v[152:155], v[228:235], v3
    v_sub_f32 v208, v208, v4
    v_exp_f32 v208, v208
    v_sub_f32 v209, v209, v4
    v_exp_f32 v209, v209
    v_sub_f32 v210, v210, v4
    v_exp_f32 v210, v210
    v_mfma_f32_32x32x16_bf16 v[220:235], v[56:59], v[8:11], 0
    v_sub_f32 v211, v211, v4
    v_exp_f32 v211, v211
    v_sub_f32 v212, v212, v4
    v_exp_f32 v212, v212
    v_sub_f32 v213, v213, v4
    v_exp_f32 v213, v213
    v_smfmac_f32_32x32x32_bf16 v[236:251], v[156:159], v[204:211], v3
    s_setprio 0
    v_sub_f32 v214, v214, v4
    v_exp_f32 v214, v214
    v_sub_f32 v215, v215, v4
    v_exp_f32 v215, v215
    v_sub_f32 v216, v216, v4
    v_exp_f32 v216, v216
    v_sub_f32 v217, v217, v4
    v_exp_f32 v217, v217
    v_sub_f32 v218, v218, v4
    v_exp_f32 v218, v218
    v_sub_f32 v219, v219, v4
    v_exp_f32 v219, v219
    s_setprio 2
    v_sub_f32 v220, v220, v4
    v_exp_f32 v220, v220
    v_sub_f32 v221, v221, v4
    v_exp_f32 v221, v221
    v_sub_f32 v222, v222, v4
    v_exp_f32 v222, v222
    v_sub_f32 v223, v223, v4
    v_exp_f32 v223, v223
    v_smfmac_f32_32x32x32_bf16 v[236:251], v[160:163], v[212:219], v3
    v_sub_f32 v224, v224, v4
    v_exp_f32 v224, v224
    v_sub_f32 v225, v225, v4
    v_exp_f32 v225, v225
    v_sub_f32 v226, v226, v4
    v_exp_f32 v226, v226
    v_mfma_f32_32x32x16_bf16 v[204:219], v[60:63], v[8:11], 0
    v_sub_f32 v227, v227, v4
    v_exp_f32 v227, v227
    v_sub_f32 v228, v228, v4
    v_exp_f32 v228, v228
    v_sub_f32 v229, v229, v4
    v_exp_f32 v229, v229
    v_smfmac_f32_32x32x32_bf16 v[236:251], v[164:167], v[220:227], v3
    s_setprio 0
    v_sub_f32 v230, v230, v4
    v_exp_f32 v230, v230
    v_sub_f32 v231, v231, v4
    v_exp_f32 v231, v231
    v_sub_f32 v232, v232, v4
    v_exp_f32 v232, v232
    v_sub_f32 v233, v233, v4
    v_exp_f32 v233, v233
    v_sub_f32 v234, v234, v4
    v_exp_f32 v234, v234
    v_sub_f32 v235, v235, v4
    v_exp_f32 v235, v235
    s_setprio 2
    v_sub_f32 v204, v204, v4
    v_exp_f32 v204, v204
    v_sub_f32 v205, v205, v4
    v_exp_f32 v205, v205
    v_sub_f32 v206, v206, v4
    v_exp_f32 v206, v206
    v_sub_f32 v207, v207, v4
    v_exp_f32 v207, v207
    v_smfmac_f32_32x32x32_bf16 v[236:251], v[168:171], v[228:235], v3
    v_sub_f32 v208, v208, v4
    v_exp_f32 v208, v208
    v_sub_f32 v209, v209, v4
    v_exp_f32 v209, v209
    v_sub_f32 v210, v210, v4
    v_exp_f32 v210, v210
    v_mfma_f32_32x32x16_bf16 v[220:235], v[64:67], v[8:11], 0
    v_sub_f32 v211, v211, v4
    v_exp_f32 v211, v211
    v_sub_f32 v212, v212, v4
    v_exp_f32 v212, v212
    v_sub_f32 v213, v213, v4
    v_exp_f32 v213, v213
    v_smfmac_f32_32x32x32_bf16 v[236:251], v[172:175], v[204:211], v3
    s_setprio 0
    v_sub_f32 v214, v214, v4
    v_exp_f32 v214, v214
    v_sub_f32 v215, v215, v4
    v_exp_f32 v215, v215
    v_sub_f32 v216, v216, v4
    v_exp_f32 v216, v216
    v_sub_f32 v217, v217, v4
    v_exp_f32 v217, v217
    v_sub_f32 v218, v218, v4
    v_exp_f32 v218, v218
    v_sub_f32 v219, v219, v4
    v_exp_f32 v219, v219
    s_setprio 2
    v_sub_f32 v220, v220, v4
    v_exp_f32 v220, v220
    v_sub_f32 v221, v221, v4
    v_exp_f32 v221, v221
    v_sub_f32 v222, v222, v4
    v_exp_f32 v222, v222
    v_sub_f32 v223, v223, v4
    v_exp_f32 v223, v223
    v_smfmac_f32_32x32x32_bf16 v[236:251], v[176:179], v[212:219], v3
    v_sub_f32 v224, v224, v4
    v_exp_f32 v224, v224
    v_sub_f32 v225, v225, v4
    v_exp_f32 v225, v225
    v_sub_f32 v226, v226, v4
    v_exp_f32 v226, v226
    v_mfma_f32_32x32x16_bf16 v[204:219], v[68:71], v[8:11], 0
    v_sub_f32 v227, v227, v4
    v_exp_f32 v227, v227
    v_sub_f32 v228, v228, v4
    v_exp_f32 v228, v228
    v_sub_f32 v229, v229, v4
    v_exp_f32 v229, v229
    v_smfmac_f32_32x32x32_bf16 v[236:251], v[180:183], v[220:227], v3
    s_setprio 0
    v_sub_f32 v230, v230, v4
    v_exp_f32 v230, v230
    v_sub_f32 v231, v231, v4
    v_exp_f32 v231, v231
    v_sub_f32 v232, v232, v4
    v_exp_f32 v232, v232
    v_sub_f32 v233, v233, v4
    v_exp_f32 v233, v233
    v_sub_f32 v234, v234, v4
    v_exp_f32 v234, v234
    v_sub_f32 v235, v235, v4
    v_exp_f32 v235, v235
    s_setprio 2
    v_sub_f32 v204, v204, v4
    v_exp_f32 v204, v204
    v_sub_f32 v205, v205, v4
    v_exp_f32 v205, v205
    v_sub_f32 v206, v206, v4
    v_exp_f32 v206, v206
    v_sub_f32 v207, v207, v4
    v_exp_f32 v207, v207
    v_smfmac_f32_32x32x32_bf16 v[236:251], v[184:187], v[228:235], v3
    v_sub_f32 v208, v208, v4
    v_exp_f32 v208, v208
    v_sub_f32 v209, v209, v4
    v_exp_f32 v209, v209
    v_sub_f32 v210, v210, v4
    v_exp_f32 v210, v210
    v_mfma_f32_32x32x16_bf16 v[220:235], v[72:75], v[8:11], 0
    v_add_u32 v2, 1024, v2
    v_add_u32 v6, 128, v6
    ds_read_b128 v[8:11], v2
    ds_read_b32 v5, v6
    v_sub_f32 v211, v211, v4
    v_exp_f32 v211, v211
    v_sub_f32 v212, v212, v4
    v_exp_f32 v212, v212
    v_sub_f32 v213, v213, v4
    v_exp_f32 v213, v213
    v_smfmac_f32_32x32x32_bf16 v[236:251], v[188:191], v[204:211], v3
    s_setprio 0
    v_sub_f32 v214, v214, v4
    v_exp_f32 v214, v214
    v_sub_f32 v215, v215, v4
    v_exp_f32 v215, v215
    v_sub_f32 v216, v216, v4
    v_exp_f32 v216, v216
    v_sub_f32 v217, v217, v4
    v_exp_f32 v217, v217
    v_sub_f32 v218, v218, v4
    v_exp_f32 v218, v218
    v_sub_f32 v219, v219, v4
    v_exp_f32 v219, v219
    s_setprio 2
    v_sub_f32 v220, v220, v4
    v_exp_f32 v220, v220
    v_sub_f32 v221, v221, v4
    v_exp_f32 v221, v221
    v_sub_f32 v222, v222, v4
    v_exp_f32 v222, v222
    v_sub_f32 v223, v223, v4
    v_exp_f32 v223, v223
    v_smfmac_f32_32x32x32_bf16 v[236:251], v[192:195], v[212:219], v3
    v_sub_f32 v224, v224, v4
    v_exp_f32 v224, v224
    v_sub_f32 v225, v225, v4
    v_exp_f32 v225, v225
    v_sub_f32 v226, v226, v4
    v_exp_f32 v226, v226
    s_waitcnt lgkmcnt(0)
    v_mfma_f32_32x32x16_bf16 v[204:219], v[12:15], v[8:11], 0
    v_sub_f32 v227, v227, v4
    v_exp_f32 v227, v227
    v_sub_f32 v228, v228, v4
    v_exp_f32 v228, v228
    v_sub_f32 v229, v229, v4
    v_exp_f32 v229, v229
    v_smfmac_f32_32x32x32_bf16 v[236:251], v[196:199], v[220:227], v3
    s_setprio 0
    v_sub_f32 v230, v230, v4
    v_exp_f32 v230, v230
    v_sub_f32 v231, v231, v4
    v_exp_f32 v231, v231
    v_sub_f32 v232, v232, v4
    v_exp_f32 v232, v232
    v_sub_f32 v233, v233, v4
    v_exp_f32 v233, v233
    v_sub_f32 v234, v234, v4
    v_exp_f32 v234, v234
    v_sub_f32 v235, v235, v4
    v_exp_f32 v235, v235
    v_mov_b32 v4, v5
    s_add_u32 s60, s60, 1
    s_cmp_lg_u32 s60, 8
    s_cbranch_scc1 A_f_loop
    s_branch A_fin
G_start:
    s_sub_u32 s6, s3, 4
    s_cmp_eq_u32 s5, 7
    s_cbranch_scc0 G_ffn1
    s_setprio 3
    s_and_b32 s7, s6, 1
    v_and_b32 v4, 31, v1
    v_lshrrev_b32 v5, 5, v1
    v_and_b32 v16, 15, v1
    v_xor_b32 v16, v16, v5
    v_lshlrev_b32 v16, 4, v16
    v_lshl_add_u32 v16, v4, 10, v16
    s_lshl_b32 s52, s7, 15
    s_add_u32 s52, s52, 0
    v_add_u32 v16, s52, v16
    v_xor_b32 v17, 32, v16
    v_xor_b32 v18, 64, v16
    v_xor_b32 v19, 96, v16
    v_xor_b32 v20, 128, v16
    v_xor_b32 v21, 160, v16
    v_xor_b32 v22, 192, v16
    v_xor_b32 v23, 224, v16
    v_bfe_u32 v7, v1, 2, 2
    v_and_b32 v8, 3, v1
    v_lshl_add_u32 v10, v5, 3, v7
    s_cmp_lt_u32 s6, 2
    s_mov_b32 s50, 131072
    s_cselect_b32 s50, 65536, s50
    v_lshlrev_b32 v12, 5, v10
    v_lshl_add_u32 v12, v8, 3, v12
    v_add_u32 v12, s50, v12
    s_lshl_b32 s51, s4, 1
    s_add_u32 s51, s51, s7
    s_lshl_b32 s56, s51, 3
    s_lshr_b32 s52, s6, 1
    s_lshl_b32 s52, s52, 2
    s_add_u32 s56, s56, s52
    s_add_u32 s56, s56, 2260992
    s_lshl_b32 s54, s4, 11
    s_lshl_b32 s55, s7, 10
    s_add_u32 s54, s54, s55
    s_add_u32 s54, s54, 2293760
    v_mov_b64 v[68:69], 0
    v_mov_b64 v[70:71], 0
    buffer_store_dwordx4 v[68:71], v2, s[44:47], s54 offen sc1
    s_waitcnt vmcnt(1)
    s_barrier
    v_mov_b32 v121, 128
    global_load_dword v120, v121, s[48:49] sc1
    s_cmp_ge_u32 s6, 2
    s_cbranch_scc1 G_v
    ds_read_b128 v[68:71], v16 offset:0
    ds_read_b64_tr_b16 v[64:65], v12 offset:0
    ds_read_b64_tr_b16 v[66:67], v12 offset:128
    ds_read_b128 v[76:79], v17 offset:0
    ds_read_b64_tr_b16 v[72:73], v12 offset:512
    ds_read_b64_tr_b16 v[74:75], v12 offset:640
    ds_read_b128 v[84:87], v18 offset:0
    ds_read_b64_tr_b16 v[80:81], v12 offset:1024
    ds_read_b64_tr_b16 v[82:83], v12 offset:1152
    ds_read_b128 v[92:95], v19 offset:0
    ds_read_b64_tr_b16 v[88:89], v12 offset:1536
    ds_read_b64_tr_b16 v[90:91], v12 offset:1664
    ds_read_b128 v[100:103], v20 offset:0
    ds_read_b64_tr_b16 v[96:97], v12 offset:2048
    ds_read_b64_tr_b16 v[98:99], v12 offset:2176
    ds_read_b128 v[108:111], v21 offset:0
    ds_read_b64_tr_b16 v[104:105], v12 offset:2560
    ds_read_b64_tr_b16 v[106:107], v12 offset:2688
    s_waitcnt lgkmcnt(15)
    v_mfma_f32_32x32x16_bf16 v[32:47], v[64:67], v[68:71], 0
    ds_read_b128 v[68:71], v22 offset:0
    ds_read_b64_tr_b16 v[64:65], v12 offset:3072
    ds_read_b64_tr_b16 v[66:67], v12 offset:3200
    s_waitcnt lgkmcnt(15)
    v_mfma_f32_32x32x16_bf16 v[32:47], v[72:75], v[76:79], v[32:47]
    ds_read_b128 v[76:79], v23 offset:0
    ds_read_b64_tr_b16 v[72:73], v12 offset:3584
    ds_read_b64_tr_b16 v[74:75], v12 offset:3712
    s_waitcnt lgkmcnt(15)
    v_mfma_f32_32x32x16_bf16 v[32:47], v[80:83], v[84:87], v[32:47]
    ds_read_b128 v[84:87], v16 offset:256
    ds_read_b64_tr_b16 v[80:81], v12 offset:4096
    ds_read_b64_tr_b16 v[82:83], v12 offset:4224
    s_waitcnt lgkmcnt(15)
    v_mfma_f32_32x32x16_bf16 v[32:47], v[88:91], v[92:95], v[32:47]
    ds_read_b128 v[92:95], v17 offset:256
    ds_read_b64_tr_b16 v[88:89], v12 offset:4608
    ds_read_b64_tr_b16 v[90:91], v12 offset:4736
    s_waitcnt lgkmcnt(15)
    v_mfma_f32_32x32x16_bf16 v[32:47], v[96:99], v[100:103], v[32:47]
    ds_read_b128 v[100:103], v18 offset:256
    ds_read_b64_tr_b16 v[96:97], v12 offset:5120
    ds_read_b64_tr_b16 v[98:99], v12 offset:5248
    s_waitcnt lgkmcnt(15)
    v_mfma_f32_32x32x16_bf16 v[32:47], v[104:107], v[108:111], v[32:47]
    ds_read_b128 v[108:111], v19 offset:256
    ds_read_b64_tr_b16 v[104:105], v12 offset:5632
    ds_read_b64_tr_b16 v[106:107], v12 offset:5760
    s_waitcnt lgkmcnt(15)
    v_mfma_f32_32x32x16_bf16 v[32:47], v[64:67], v[68:71], v[32:47]
    ds_read_b128 v[68:71], v20 offset:256
    ds_read_b64_tr_b16 v[64:65], v12 offset:6144
    ds_read_b64_tr_b16 v[66:67], v12 offset:6272
    s_waitcnt lgkmcnt(15)
    v_mfma_f32_32x32x16_bf16 v[32:47], v[72:75], v[76:79], v[32:47]
    ds_read_b128 v[76:79], v21 offset:256
    ds_read_b64_tr_b16 v[72:73], v12 offset:6656
    ds_read_b64_tr_b16 v[74:75], v12 offset:6784
    s_waitcnt lgkmcnt(15)
    v_mfma_f32_32x32x16_bf16 v[32:47], v[80:83], v[84:87], v[32:47]
    ds_read_b128 v[84:87], v22 offset:256
    ds_read_b64_tr_b16 v[80:81], v12 offset:7168
    ds_read_b64_tr_b16 v[82:83], v12 offset:7296
    s_waitcnt lgkmcnt(15)
    v_mfma_f32_32x32x16_bf16 v[32:47], v[88:91], v[92:95], v[32:47]
    ds_read_b128 v[92:95], v23 offset:256
    ds_read_b64_tr_b16 v[88:89], v12 offset:7680
    ds_read_b64_tr_b16 v[90:91], v12 offset:7808
    s_waitcnt lgkmcnt(15)
    v_mfma_f32_32x32x16_bf16 v[32:47], v[96:99], v[100:103], v[32:47]
    ds_read_b128 v[100:103], v16 offset:512
    ds_read_b64_tr_b16 v[96:97], v12 offset:8192
    ds_read_b64_tr_b16 v[98:99], v12 offset:8320
    s_waitcnt lgkmcnt(15)
    v_mfma_f32_32x32x16_bf16 v[32:47], v[104:107], v[108:111], v[32:47]
    ds_read_b128 v[108:111], v17 offset:512
    ds_read_b64_tr_b16 v[104:105], v12 offset:8704
    ds_read_b64_tr_b16 v[106:107], v12 offset:8832
    s_waitcnt lgkmcnt(15)
    v_mfma_f32_32x32x16_bf16 v[32:47], v[64:67], v[68:71], v[32:47]
    ds_read_b128 v[68:71], v18 offset:512
    ds_read_b64_tr_b16 v[64:65], v12 offset:9216
    ds_read_b64_tr_b16 v[66:67], v12 offset:9344
    s_waitcnt lgkmcnt(15)
    v_mfma_f32_32x32x16_bf16 v[32:47], v[72:75], v[76:79], v[32:47]
    ds_read_b128 v[76:79], v19 offset:512
    ds_read_b64_tr_b16 v[72:73], v12 offset:9728
    ds_read_b64_tr_b16 v[74:75], v12 offset:9856
    s_waitcnt lgkmcnt(15)
    v_mfma_f32_32x32x16_bf16 v[32:47], v[80:83], v[84:87], v[32:47]
    ds_read_b128 v[84:87], v20 offset:512
    ds_read_b64_tr_b16 v[80:81], v12 offset:10240
    ds_read_b64_tr_b16 v[82:83], v12 offset:10368
    s_waitcnt lgkmcnt(15)
    v_mfma_f32_32x32x16_bf16 v[32:47], v[88:91], v[92:95], v[32:47]
    ds_read_b128 v[92:95], v21 offset:512
    ds_read_b64_tr_b16 v[88:89], v12 offset:10752
    ds_read_b64_tr_b16 v[90:91], v12 offset:10880
    s_waitcnt lgkmcnt(15)
    v_mfma_f32_32x32x16_bf16 v[32:47], v[96:99], v[100:103], v[32:47]
    ds_read_b128 v[100:103], v22 offset:512
    ds_read_b64_tr_b16 v[96:97], v12 offset:11264
    ds_read_b64_tr_b16 v[98:99], v12 offset:11392
    s_waitcnt lgkmcnt(15)
    v_mfma_f32_32x32x16_bf16 v[32:47], v[104:107], v[108:111], v[32:47]
    ds_read_b128 v[108:111], v23 offset:512
    ds_read_b64_tr_b16 v[104:105], v12 offset:11776
    ds_read_b64_tr_b16 v[106:107], v12 offset:11904
    s_waitcnt lgkmcnt(15)
    v_mfma_f32_32x32x16_bf16 v[32:47], v[64:67], v[68:71], v[32:47]
    ds_read_b128 v[68:71], v16 offset:768
    ds_read_b64_tr_b16 v[64:65], v12 offset:12288
    ds_read_b64_tr_b16 v[66:67], v12 offset:12416
    s_waitcnt lgkmcnt(15)
    v_mfma_f32_32x32x16_bf16 v[32:47], v[72:75], v[76:79], v[32:47]
    ds_read_b128 v[76:79], v17 offset:768
    ds_read_b64_tr_b16 v[72:73], v12 offset:12800
    ds_read_b64_tr_b16 v[74:75], v12 offset:12928
    s_waitcnt lgkmcnt(15)
    v_mfma_f32_32x32x16_bf16 v[32:47], v[80:83], v[84:87], v[32:47]
    ds_read_b128 v[84:87], v18 offset:768
    ds_read_b64_tr_b16 v[80:81], v12 offset:13312
    ds_read_b64_tr_b16 v[82:83], v12 offset:13440
    s_waitcnt lgkmcnt(15)
    v_mfma_f32_32x32x16_bf16 v[32:47], v[88:91], v[92:95], v[32:47]
    ds_read_b128 v[92:95], v19 offset:768
    ds_read_b64_tr_b16 v[88:89], v12 offset:13824
    ds_read_b64_tr_b16 v[90:91], v12 offset:13952
    s_waitcnt lgkmcnt(15)
    v_mfma_f32_32x32x16_bf16 v[32:47], v[96:99], v[100:103], v[32:47]
    ds_read_b128 v[100:103], v20 offset:768
    ds_read_b64_tr_b16 v[96:97], v12 offset:14336
    ds_read_b64_tr_b16 v[98:99], v12 offset:14464
    s_waitcnt lgkmcnt(15)
    v_mfma_f32_32x32x16_bf16 v[32:47], v[104:107], v[108:111], v[32:47]
    ds_read_b128 v[108:111], v21 offset:768
    ds_read_b64_tr_b16 v[104:105], v12 offset:14848
    ds_read_b64_tr_b16 v[106:107], v12 offset:14976
    s_waitcnt lgkmcnt(15)
    v_mfma_f32_32x32x16_bf16 v[32:47], v[64:67], v[68:71], v[32:47]
    ds_read_b128 v[68:71], v22 offset:768
    ds_read_b64_tr_b16 v[64:65], v12 offset:15360
    ds_read_b64_tr_b16 v[66:67], v12 offset:15488
    s_waitcnt lgkmcnt(15)
    v_mfma_f32_32x32x16_bf16 v[32:47], v[72:75], v[76:79], v[32:47]
    ds_read_b128 v[76:79], v23 offset:768
    ds_read_b64_tr_b16 v[72:73], v12 offset:15872
    ds_read_b64_tr_b16 v[74:75], v12 offset:16000
    s_waitcnt lgkmcnt(15)
    v_mfma_f32_32x32x16_bf16 v[32:47], v[80:83], v[84:87], v[32:47]
    s_waitcnt lgkmcnt(12)
    v_mfma_f32_32x32x16_bf16 v[32:47], v[88:91], v[92:95], v[32:47]
    s_waitcnt lgkmcnt(9)
    v_mfma_f32_32x32x16_bf16 v[32:47], v[96:99], v[100:103], v[32:47]
    s_waitcnt lgkmcnt(6)
    v_mfma_f32_32x32x16_bf16 v[32:47], v[104:107], v[108:111], v[32:47]
    s_waitcnt lgkmcnt(3)
    v_mfma_f32_32x32x16_bf16 v[32:47], v[64:67], v[68:71], v[32:47]
    s_waitcnt lgkmcnt(0)
    v_mfma_f32_32x32x16_bf16 v[32:47], v[72:75], v[76:79], v[32:47]
    s_nop 15
    s_nop 3
    v_mov_b32 v14, 162064
    v_mov_b32 v15, 1
    s_mov_b64 exec, 1
    ds_add_u32 v14, v15
    s_mov_b64 exec, -1
    s_mov_b32 s54, 0x3eb8aa3b
    v_mul_f32 v32, s54, v32
    v_mul_f32 v33, s54, v33
    v_mul_f32 v34, s54, v34
    v_mul_f32 v35, s54, v35
    v_mul_f32 v36, s54, v36
    v_mul_f32 v37, s54, v37
    v_mul_f32 v38, s54, v38
    v_mul_f32 v39, s54, v39
    v_cvt_pk_bf16_f32 v64, v32, v33
    v_cvt_pk_bf16_f32 v65, v34, v35
    v_cvt_pk_bf16_f32 v66, v36, v37
    v_cvt_pk_bf16_f32 v67, v38, v39
    v_and_b32 v26, 0x33, v1
    v_bfe_u32 v27, v1, 2, 1
    v_lshl_or_b32 v26, v27, 3, v26
    v_bfe_u32 v27, v1, 3, 1
    v_lshl_or_b32 v26, v27, 2, v26
    v_lshlrev_b32 v26, 4, v26
    s_lshl_b32 s54, s51, 10
    s_add_u32 s54, s54, 2097152
    buffer_store_dwordx4 v[64:67], v26, s[44:47], s54 offen sc1
    v_mul_f32 v24, v32, v32
    v_fmac_f32 v24, v33, v33
    v_fmac_f32 v24, v34, v34
    v_fmac_f32 v24, v35, v35
    v_fmac_f32 v24, v36, v36
    v_fmac_f32 v24, v37, v37
    v_fmac_f32 v24, v38, v38
    v_fmac_f32 v24, v39, v39
    v_mov_b32 v27, v24
    s_nop 1
    v_permlane32_swap_b32 v24, v27
    s_nop 1
    v_add_f32 v24, v24, v27
    s_branch G_kvpub
G_v:
    ds_read_b128 v[68:71], v16 offset:0
    ds_read_b64_tr_b16 v[64:65], v12 offset:0
    ds_read_b64_tr_b16 v[66:67], v12 offset:128
    ds_read_b128 v[76:79], v17 offset:0
    ds_read_b64_tr_b16 v[72:73], v12 offset:512
    ds_read_b64_tr_b16 v[74:75], v12 offset:640
    ds_read_b128 v[84:87], v18 offset:0
    ds_read_b64_tr_b16 v[80:81], v12 offset:1024
    ds_read_b64_tr_b16 v[82:83], v12 offset:1152
    ds_read_b128 v[92:95], v19 offset:0
    ds_read_b64_tr_b16 v[88:89], v12 offset:1536
    ds_read_b64_tr_b16 v[90:91], v12 offset:1664
    ds_read_b128 v[100:103], v20 offset:0
    ds_read_b64_tr_b16 v[96:97], v12 offset:2048
    ds_read_b64_tr_b16 v[98:99], v12 offset:2176
    ds_read_b128 v[108:111], v21 offset:0
    ds_read_b64_tr_b16 v[104:105], v12 offset:2560
    ds_read_b64_tr_b16 v[106:107], v12 offset:2688
    s_waitcnt lgkmcnt(15)
    v_mfma_f32_32x32x16_bf16 v[32:47], v[68:71], v[64:67], 0
    ds_read_b128 v[68:71], v22 offset:0
    ds_read_b64_tr_b16 v[64:65], v12 offset:3072
    ds_read_b64_tr_b16 v[66:67], v12 offset:3200
    s_waitcnt lgkmcnt(15)
    v_mfma_f32_32x32x16_bf16 v[32:47], v[76:79], v[72:75], v[32:47]
    ds_read_b128 v[76:79], v23 offset:0
    ds_read_b64_tr_b16 v[72:73], v12 offset:3584
    ds_read_b64_tr_b16 v[74:75], v12 offset:3712
    s_waitcnt lgkmcnt(15)
    v_mfma_f32_32x32x16_bf16 v[32:47], v[84:87], v[80:83], v[32:47]
    ds_read_b128 v[84:87], v16 offset:256
    ds_read_b64_tr_b16 v[80:81], v12 offset:4096
    ds_read_b64_tr_b16 v[82:83], v12 offset:4224
    s_waitcnt lgkmcnt(15)
    v_mfma_f32_32x32x16_bf16 v[32:47], v[92:95], v[88:91], v[32:47]
    ds_read_b128 v[92:95], v17 offset:256
    ds_read_b64_tr_b16 v[88:89], v12 offset:4608
    ds_read_b64_tr_b16 v[90:91], v12 offset:4736
    s_waitcnt lgkmcnt(15)
    v_mfma_f32_32x32x16_bf16 v[32:47], v[100:103], v[96:99], v[32:47]
    ds_read_b128 v[100:103], v18 offset:256
    ds_read_b64_tr_b16 v[96:97], v12 offset:5120
    ds_read_b64_tr_b16 v[98:99], v12 offset:5248
    s_waitcnt lgkmcnt(15)
    v_mfma_f32_32x32x16_bf16 v[32:47], v[108:111], v[104:107], v[32:47]
    ds_read_b128 v[108:111], v19 offset:256
    ds_read_b64_tr_b16 v[104:105], v12 offset:5632
    ds_read_b64_tr_b16 v[106:107], v12 offset:5760
    s_waitcnt lgkmcnt(15)
    v_mfma_f32_32x32x16_bf16 v[32:47], v[68:71], v[64:67], v[32:47]
    ds_read_b128 v[68:71], v20 offset:256
    ds_read_b64_tr_b16 v[64:65], v12 offset:6144
    ds_read_b64_tr_b16 v[66:67], v12 offset:6272
    s_waitcnt lgkmcnt(15)
    v_mfma_f32_32x32x16_bf16 v[32:47], v[76:79], v[72:75], v[32:47]
    ds_read_b128 v[76:79], v21 offset:256
    ds_read_b64_tr_b16 v[72:73], v12 offset:6656
    ds_read_b64_tr_b16 v[74:75], v12 offset:6784
    s_waitcnt lgkmcnt(15)
    v_mfma_f32_32x32x16_bf16 v[32:47], v[84:87], v[80:83], v[32:47]
    ds_read_b128 v[84:87], v22 offset:256
    ds_read_b64_tr_b16 v[80:81], v12 offset:7168
    ds_read_b64_tr_b16 v[82:83], v12 offset:7296
    s_waitcnt lgkmcnt(15)
    v_mfma_f32_32x32x16_bf16 v[32:47], v[92:95], v[88:91], v[32:47]
    ds_read_b128 v[92:95], v23 offset:256
    ds_read_b64_tr_b16 v[88:89], v12 offset:7680
    ds_read_b64_tr_b16 v[90:91], v12 offset:7808
    s_waitcnt lgkmcnt(15)
    v_mfma_f32_32x32x16_bf16 v[32:47], v[100:103], v[96:99], v[32:47]
    ds_read_b128 v[100:103], v16 offset:512
    ds_read_b64_tr_b16 v[96:97], v12 offset:8192
    ds_read_b64_tr_b16 v[98:99], v12 offset:8320
    s_waitcnt lgkmcnt(15)
    v_mfma_f32_32x32x16_bf16 v[32:47], v[108:111], v[104:107], v[32:47]
    ds_read_b128 v[108:111], v17 offset:512
    ds_read_b64_tr_b16 v[104:105], v12 offset:8704
    ds_read_b64_tr_b16 v[106:107], v12 offset:8832
    s_waitcnt lgkmcnt(15)
    v_mfma_f32_32x32x16_bf16 v[32:47], v[68:71], v[64:67], v[32:47]
    ds_read_b128 v[68:71], v18 offset:512
    ds_read_b64_tr_b16 v[64:65], v12 offset:9216
    ds_read_b64_tr_b16 v[66:67], v12 offset:9344
    s_waitcnt lgkmcnt(15)
    v_mfma_f32_32x32x16_bf16 v[32:47], v[76:79], v[72:75], v[32:47]
    ds_read_b128 v[76:79], v19 offset:512
    ds_read_b64_tr_b16 v[72:73], v12 offset:9728
    ds_read_b64_tr_b16 v[74:75], v12 offset:9856
    s_waitcnt lgkmcnt(15)
    v_mfma_f32_32x32x16_bf16 v[32:47], v[84:87], v[80:83], v[32:47]
    ds_read_b128 v[84:87], v20 offset:512
    ds_read_b64_tr_b16 v[80:81], v12 offset:10240
    ds_read_b64_tr_b16 v[82:83], v12 offset:10368
    s_waitcnt lgkmcnt(15)
    v_mfma_f32_32x32x16_bf16 v[32:47], v[92:95], v[88:91], v[32:47]
    ds_read_b128 v[92:95], v21 offset:512
    ds_read_b64_tr_b16 v[88:89], v12 offset:10752
    ds_read_b64_tr_b16 v[90:91], v12 offset:10880
    s_waitcnt lgkmcnt(15)
    v_mfma_f32_32x32x16_bf16 v[32:47], v[100:103], v[96:99], v[32:47]
    ds_read_b128 v[100:103], v22 offset:512
    ds_read_b64_tr_b16 v[96:97], v12 offset:11264
    ds_read_b64_tr_b16 v[98:99], v12 offset:11392
    s_waitcnt lgkmcnt(15)
    v_mfma_f32_32x32x16_bf16 v[32:47], v[108:111], v[104:107], v[32:47]
    ds_read_b128 v[108:111], v23 offset:512
    ds_read_b64_tr_b16 v[104:105], v12 offset:11776
    ds_read_b64_tr_b16 v[106:107], v12 offset:11904
    s_waitcnt lgkmcnt(15)
    v_mfma_f32_32x32x16_bf16 v[32:47], v[68:71], v[64:67], v[32:47]
    ds_read_b128 v[68:71], v16 offset:768
    ds_read_b64_tr_b16 v[64:65], v12 offset:12288
    ds_read_b64_tr_b16 v[66:67], v12 offset:12416
    s_waitcnt lgkmcnt(15)
    v_mfma_f32_32x32x16_bf16 v[32:47], v[76:79], v[72:75], v[32:47]
    ds_read_b128 v[76:79], v17 offset:768
    ds_read_b64_tr_b16 v[72:73], v12 offset:12800
    ds_read_b64_tr_b16 v[74:75], v12 offset:12928
    s_waitcnt lgkmcnt(15)
    v_mfma_f32_32x32x16_bf16 v[32:47], v[84:87], v[80:83], v[32:47]
    ds_read_b128 v[84:87], v18 offset:768
    ds_read_b64_tr_b16 v[80:81], v12 offset:13312
    ds_read_b64_tr_b16 v[82:83], v12 offset:13440
    s_waitcnt lgkmcnt(15)
    v_mfma_f32_32x32x16_bf16 v[32:47], v[92:95], v[88:91], v[32:47]
    ds_read_b128 v[92:95], v19 offset:768
    ds_read_b64_tr_b16 v[88:89], v12 offset:13824
    ds_read_b64_tr_b16 v[90:91], v12 offset:13952
    s_waitcnt lgkmcnt(15)
    v_mfma_f32_32x32x16_bf16 v[32:47], v[100:103], v[96:99], v[32:47]
    ds_read_b128 v[100:103], v20 offset:768
    ds_read_b64_tr_b16 v[96:97], v12 offset:14336
    ds_read_b64_tr_b16 v[98:99], v12 offset:14464
    s_waitcnt lgkmcnt(15)
    v_mfma_f32_32x32x16_bf16 v[32:47], v[108:111], v[104:107], v[32:47]
    ds_read_b128 v[108:111], v21 offset:768
    ds_read_b64_tr_b16 v[104:105], v12 offset:14848
    ds_read_b64_tr_b16 v[106:107], v12 offset:14976
    s_waitcnt lgkmcnt(15)
    v_mfma_f32_32x32x16_bf16 v[32:47], v[68:71], v[64:67], v[32:47]
    ds_read_b128 v[68:71], v22 offset:768
    ds_read_b64_tr_b16 v[64:65], v12 offset:15360
    ds_read_b64_tr_b16 v[66:67], v12 offset:15488
    s_waitcnt lgkmcnt(15)
    v_mfma_f32_32x32x16_bf16 v[32:47], v[76:79], v[72:75], v[32:47]
    ds_read_b128 v[76:79], v23 offset:768
    ds_read_b64_tr_b16 v[72:73], v12 offset:15872
    ds_read_b64_tr_b16 v[74:75], v12 offset:16000
    s_waitcnt lgkmcnt(15)
    v_mfma_f32_32x32x16_bf16 v[32:47], v[84:87], v[80:83], v[32:47]
    s_waitcnt lgkmcnt(12)
    v_mfma_f32_32x32x16_bf16 v[32:47], v[92:95], v[88:91], v[32:47]
    s_waitcnt lgkmcnt(9)
    v_mfma_f32_32x32x16_bf16 v[32:47], v[100:103], v[96:99], v[32:47]
    s_waitcnt lgkmcnt(6)
    v_mfma_f32_32x32x16_bf16 v[32:47], v[108:111], v[104:107], v[32:47]
    s_waitcnt lgkmcnt(3)
    v_mfma_f32_32x32x16_bf16 v[32:47], v[68:71], v[64:67], v[32:47]
    s_waitcnt lgkmcnt(0)
    v_mfma_f32_32x32x16_bf16 v[32:47], v[76:79], v[72:75], v[32:47]
    s_nop 15
    s_nop 3
    v_mov_b32 v14, 162064
    v_mov_b32 v15, 1
    s_mov_b64 exec, 1
    ds_add_u32 v14, v15
    s_mov_b64 exec, -1
    v_cvt_pk_bf16_f32 v64, v32, v33
    v_cvt_pk_bf16_f32 v65, v34, v35
    v_cvt_pk_bf16_f32 v66, v36, v37
    v_cvt_pk_bf16_f32 v67, v38, v39
    v_cvt_pk_bf16_f32 v68, v40, v41
    v_cvt_pk_bf16_f32 v69, v42, v43
    v_cvt_pk_bf16_f32 v70, v44, v45
    v_cvt_pk_bf16_f32 v71, v46, v47
    v_and_b32 v26, 15, v1
    v_lshlrev_b32 v26, 4, v26
    v_lshl_add_u32 v26, v5, 8, v26
    s_lshl_b32 s54, s51, 10
    s_add_u32 s54, s54, 2162688
    s_mov_b32 s55, 0x0000ffff
    s_mov_b32 exec_lo, s55
    s_mov_b32 exec_hi, s55
    buffer_store_dwordx4 v[64:67], v26, s[44:47], s54 offen sc1
    buffer_store_dwordx4 v[68:71], v26, s[44:47], s54 offen offset:512 sc1
    s_mov_b64 exec, -1
    v_max_f32 v24, abs(v32), abs(v33)
    v_max3_f32 v24, abs(v34), abs(v35), v24
    v_max3_f32 v24, abs(v36), abs(v37), v24
    v_max3_f32 v24, abs(v38), abs(v39), v24
    v_max3_f32 v24, abs(v40), abs(v41), v24
    v_max3_f32 v24, abs(v42), abs(v43), v24
    v_max3_f32 v24, abs(v44), abs(v45), v24
    v_max3_f32 v24, abs(v46), abs(v47), v24
G_kvpub:
    s_nop 1
    v_max_f32_dpp v24, v24, v24 row_shr:1 row_mask:0xf bank_mask:0xf
    s_nop 1
    v_max_f32_dpp v24, v24, v24 row_shr:2 row_mask:0xf bank_mask:0xf
    s_nop 1
    v_max_f32_dpp v24, v24, v24 row_shr:4 row_mask:0xf bank_mask:0xf
    s_nop 1
    v_max_f32_dpp v24, v24, v24 row_shr:8 row_mask:0xf bank_mask:0xf
    s_nop 1
    v_max_f32_dpp v24, v24, v24 row_bcast:15 row_mask:0xa bank_mask:0xf
    s_nop 1
    v_max_f32_dpp v24, v24, v24 row_bcast:31 row_mask:0xc bank_mask:0xf
    v_mov_b32 v25, 0
    s_mov_b32 exec_lo, 0
    s_mov_b32 exec_hi, 0x80000000
    buffer_store_dword v24, v25, s[44:47], s56 offen sc1
    s_mov_b64 exec, -1
    s_waitcnt vmcnt(0)
G_zp:
    v_readfirstlane_b32 s52, v120
    s_cmp_lg_u32 s52, 0
    s_cbranch_scc1 G_zpd
    global_load_dword v120, v121, s[48:49] sc1
    s_waitcnt vmcnt(0)
    s_sleep 1
    s_add_u32 s58, s58, 1
    s_cmp_lt_u32 s58, 200000
    s_cbranch_scc1 G_zp
G_zpd:
    v_mov_b32 v14, 162056
    v_mov_b32 v15, 1
    s_mov_b64 exec, 1
    ds_add_rtn_u32 v15, v14, v15
    s_mov_b64 exec, -1
    s_waitcnt lgkmcnt(0)
    v_readfirstlane_b32 s52, v15
    s_cmp_lg_u32 s52, 3
    s_cbranch_scc1 G_kvdone
    v_mov_b32 v24, 1
    v_mul_u32_u24 v14, 256, v1
    v_add_u32 v14, 2269184, v14
    s_mov_b32 exec_lo, 0xffffffff
    s_mov_b32 exec_hi, 0
    global_atomic_add v14, v24, s[30:31]
    s_mov_b64 exec, -1
G_kvdone:
    s_setprio 1
    s_nop 0
    s_branch G_pre
G_ffn1:
    s_lshl_b32 s52, s2, 3
    s_add_u32 s52, s52, s3
    s_cmp_lg_u32 s52, 263
    s_cbranch_scc1 G_nz
    v_mov_b32 v14, 128
    v_mov_b32 v15, 1
    s_waitcnt vmcnt(8)
    s_mov_b64 exec, 1
    global_store_dword v14, v15, s[48:49] sc1
    s_mov_b64 exec, -1
G_nz:
    s_mov_b32 s36, s20
    s_mov_b32 s37, s21
    s_mov_b32 s38, 0x1c0000
    s_mov_b32 s39, 0x00020000
    v_lshrrev_b32 v14, 3, v1
    v_mul_u32_u24 v14, 3584, v14
    v_and_b32 v15, 7, v1
    v_bfe_u32 v3, v1, 4, 1
    v_lshlrev_b32 v3, 2, v3
    v_xor_b32 v15, v15, v3
    v_lshl_add_u32 v3, v15, 4, v14
    s_lshl_b32 s50, s5, 9
    s_lshl_b32 s52, s6, 7
    s_add_u32 s50, s50, s52
    s_and_b32 s7, s4, 3
    s_xor_b32 s52, s7, 0
    s_mul_i32 s52, s52, 458752
    s_add_u32 s40, s50, s52
    s_xor_b32 s52, s7, 1
    s_mul_i32 s52, s52, 458752
    s_add_u32 s41, s50, s52
    s_xor_b32 s52, s7, 2
    s_mul_i32 s52, s52, 458752
    s_add_u32 s42, s50, s52
    s_xor_b32 s52, s7, 3
    s_mul_i32 s52, s52, 458752
    s_add_u32 s43, s50, s52
    s_add_u32 s53, s40, 0
    buffer_load_dwordx4 v[112:115], v3, s[36:39], s53 offen
    s_add_u32 s53, s40, 28672
    buffer_load_dwordx4 v[116:119], v3, s[36:39], s53 offen
    s_add_u32 s53, s40, 57344
    buffer_load_dwordx4 v[120:123], v3, s[36:39], s53 offen
    s_add_u32 s53, s40, 86016
    buffer_load_dwordx4 v[124:127], v3, s[36:39], s53 offen
    s_lshl_b32 s51, s6, 12
    s_add_u32 s51, s51, 65536
    v_and_b32 v14, 31, v1
    v_lshrrev_b32 v15, 5, v1
    v_and_b32 v4, 15, v1
    v_xor_b32 v4, v4, v15
    v_lshlrev_b32 v4, 4, v4
    v_lshl_add_u32 v4, v14, 10, v4
    v_add_u32 v4, 0, v4
    s_lshl_b32 s52, s7, 8
    v_or_b32 v4, s52, v4
    v_xor_b32 v5, 32, v4
    v_xor_b32 v6, 64, v4
    v_xor_b32 v7, 96, v4
    v_xor_b32 v8, 128, v4
    v_xor_b32 v9, 160, v4
    v_xor_b32 v10, 192, v4
    v_xor_b32 v11, 224, v4
    v_lshrrev_b32 v14, 5, v1
    v_bfe_u32 v15, v1, 2, 2
    v_lshl_add_u32 v14, v14, 3, v15
    v_lshlrev_b32 v14, 7, v14
    v_lshrrev_b32 v15, 1, v15
    v_lshl_add_u32 v14, v15, 6, v14
    v_bfe_u32 v15, v1, 4, 1
    v_lshl_add_u32 v14, v15, 5, v14
    v_and_b32 v15, 3, v1
    v_lshl_add_u32 v14, v15, 3, v14
    v_add_u32 v12, s51, v14
    v_xor_b32 v13, 64, v12
    v_add_u32 v240, s51, v2
    s_waitcnt vmcnt(4)
    s_waitcnt lgkmcnt(0)
    s_barrier
    s_add_u32 s53, s40, 114688
    buffer_load_dwordx4 v[128:131], v3, s[36:39], s53 offen
    s_add_u32 s53, s40, 143360
    buffer_load_dwordx4 v[132:135], v3, s[36:39], s53 offen
    s_add_u32 s53, s40, 172032
    buffer_load_dwordx4 v[136:139], v3, s[36:39], s53 offen
    s_add_u32 s53, s40, 200704
    buffer_load_dwordx4 v[140:143], v3, s[36:39], s53 offen
    s_add_u32 s53, s40, 229376
    buffer_load_dwordx4 v[144:147], v3, s[36:39], s53 offen
    s_add_u32 s53, s40, 258048
    buffer_load_dwordx4 v[148:151], v3, s[36:39], s53 offen
    s_add_u32 s53, s40, 286720
    buffer_load_dwordx4 v[152:155], v3, s[36:39], s53 offen
    s_add_u32 s53, s40, 315392
    buffer_load_dwordx4 v[156:159], v3, s[36:39], s53 offen
    s_add_u32 s53, s40, 344064
    buffer_load_dwordx4 v[160:163], v3, s[36:39], s53 offen
    s_add_u32 s53, s40, 372736
    buffer_load_dwordx4 v[164:167], v3, s[36:39], s53 offen
    s_add_u32 s53, s40, 401408
    buffer_load_dwordx4 v[168:171], v3, s[36:39], s53 offen
    s_add_u32 s53, s40, 430080
    buffer_load_dwordx4 v[172:175], v3, s[36:39], s53 offen
    s_add_u32 s53, s41, 0
    buffer_load_dwordx4 v[176:179], v3, s[36:39], s53 offen
    s_add_u32 s53, s41, 28672
    buffer_load_dwordx4 v[180:183], v3, s[36:39], s53 offen
    s_add_u32 s53, s41, 57344
    buffer_load_dwordx4 v[184:187], v3, s[36:39], s53 offen
    s_add_u32 s53, s41, 86016
    buffer_load_dwordx4 v[188:191], v3, s[36:39], s53 offen
    s_add_u32 s53, s41, 114688
    buffer_load_dwordx4 v[192:195], v3, s[36:39], s53 offen
    s_add_u32 s53, s41, 143360
    buffer_load_dwordx4 v[196:199], v3, s[36:39], s53 offen
    s_add_u32 s53, s41, 172032
    buffer_load_dwordx4 v[200:203], v3, s[36:39], s53 offen
    s_add_u32 s53, s41, 200704
    buffer_load_dwordx4 v[204:207], v3, s[36:39], s53 offen
    s_add_u32 s53, s41, 229376
    buffer_load_dwordx4 v[208:211], v3, s[36:39], s53 offen
    s_add_u32 s53, s41, 258048
    buffer_load_dwordx4 v[212:215], v3, s[36:39], s53 offen
    s_add_u32 s53, s41, 286720
    buffer_load_dwordx4 v[216:219], v3, s[36:39], s53 offen
    s_add_u32 s53, s41, 315392
    buffer_load_dwordx4 v[220:223], v3, s[36:39], s53 offen
    s_add_u32 s53, s41, 344064
    buffer_load_dwordx4 v[224:227], v3, s[36:39], s53 offen
    s_add_u32 s53, s41, 372736
    buffer_load_dwordx4 v[228:231], v3, s[36:39], s53 offen
    s_add_u32 s53, s41, 401408
    buffer_load_dwordx4 v[232:235], v3, s[36:39], s53 offen
    s_add_u32 s53, s41, 430080
    buffer_load_dwordx4 v[236:239], v3, s[36:39], s53 offen
    s_waitcnt vmcnt(30)
    ds_write_b128 v240, v[112:115] offset:0
    ds_write_b128 v240, v[116:119] offset:1024
    s_waitcnt vmcnt(28)
    ds_write_b128 v240, v[120:123] offset:2048
    ds_write_b128 v240, v[124:127] offset:3072
    ds_read_b64_tr_b16 v[80:81], v12 offset:0
    ds_read_b64_tr_b16 v[82:83], v12 offset:512
    ds_read_b64_tr_b16 v[84:85], v13 offset:0
    ds_read_b64_tr_b16 v[86:87], v13 offset:512
    ds_read_b128 v[88:91], v4 offset:0
    ds_read_b128 v[92:95], v4 offset:32768
    ds_read_b64_tr_b16 v[96:97], v12 offset:2048
    ds_read_b64_tr_b16 v[98:99], v12 offset:2560
    ds_read_b64_tr_b16 v[100:101], v13 offset:2048
    ds_read_b64_tr_b16 v[102:103], v13 offset:2560
    ds_read_b128 v[104:107], v5 offset:0
    ds_read_b128 v[108:111], v5 offset:32768
    s_waitcnt vmcnt(26)
    ds_write_b128 v240, v[128:131] offset:0
    ds_write_b128 v240, v[132:135] offset:1024
    s_waitcnt lgkmcnt(8)
    v_mfma_f32_32x32x16_bf16 v[16:31], v[80:83], v[88:91], 0
    v_mfma_f32_32x32x16_bf16 v[32:47], v[80:83], v[92:95], 0
    v_mfma_f32_32x32x16_bf16 v[48:63], v[84:87], v[88:91], 0
    v_mfma_f32_32x32x16_bf16 v[64:79], v[84:87], v[92:95], 0
    ds_read_b64_tr_b16 v[80:81], v12 offset:0
    ds_read_b64_tr_b16 v[82:83], v12 offset:512
    ds_read_b64_tr_b16 v[84:85], v13 offset:0
    ds_read_b64_tr_b16 v[86:87], v13 offset:512
    ds_read_b128 v[88:91], v6 offset:0
    ds_read_b128 v[92:95], v6 offset:32768
    s_waitcnt vmcnt(24)
    ds_write_b128 v240, v[136:139] offset:2048
    ds_write_b128 v240, v[140:143] offset:3072
    s_waitcnt lgkmcnt(8)
    v_mfma_f32_32x32x16_bf16 v[16:31], v[96:99], v[104:107], v[16:31]
    v_mfma_f32_32x32x16_bf16 v[32:47], v[96:99], v[108:111], v[32:47]
    v_mfma_f32_32x32x16_bf16 v[48:63], v[100:103], v[104:107], v[48:63]
    v_mfma_f32_32x32x16_bf16 v[64:79], v[100:103], v[108:111], v[64:79]
    ds_read_b64_tr_b16 v[96:97], v12 offset:2048
    ds_read_b64_tr_b16 v[98:99], v12 offset:2560
    ds_read_b64_tr_b16 v[100:101], v13 offset:2048
    ds_read_b64_tr_b16 v[102:103], v13 offset:2560
    ds_read_b128 v[104:107], v7 offset:0
    ds_read_b128 v[108:111], v7 offset:32768
    s_waitcnt vmcnt(22)
    ds_write_b128 v240, v[144:147] offset:0
    ds_write_b128 v240, v[148:151] offset:1024
    s_waitcnt lgkmcnt(8)
    v_mfma_f32_32x32x16_bf16 v[16:31], v[80:83], v[88:91], v[16:31]
    v_mfma_f32_32x32x16_bf16 v[32:47], v[80:83], v[92:95], v[32:47]
    v_mfma_f32_32x32x16_bf16 v[48:63], v[84:87], v[88:91], v[48:63]
    v_mfma_f32_32x32x16_bf16 v[64:79], v[84:87], v[92:95], v[64:79]
    ds_read_b64_tr_b16 v[80:81], v12 offset:0
    ds_read_b64_tr_b16 v[82:83], v12 offset:512
    ds_read_b64_tr_b16 v[84:85], v13 offset:0
    ds_read_b64_tr_b16 v[86:87], v13 offset:512
    ds_read_b128 v[88:91], v8 offset:0
    ds_read_b128 v[92:95], v8 offset:32768
    s_waitcnt vmcnt(20)
    ds_write_b128 v240, v[152:155] offset:2048
    ds_write_b128 v240, v[156:159] offset:3072
    s_waitcnt lgkmcnt(8)
    v_mfma_f32_32x32x16_bf16 v[16:31], v[96:99], v[104:107], v[16:31]
    v_mfma_f32_32x32x16_bf16 v[32:47], v[96:99], v[108:111], v[32:47]
    v_mfma_f32_32x32x16_bf16 v[48:63], v[100:103], v[104:107], v[48:63]
    v_mfma_f32_32x32x16_bf16 v[64:79], v[100:103], v[108:111], v[64:79]
    ds_read_b64_tr_b16 v[96:97], v12 offset:2048
    ds_read_b64_tr_b16 v[98:99], v12 offset:2560
    ds_read_b64_tr_b16 v[100:101], v13 offset:2048
    ds_read_b64_tr_b16 v[102:103], v13 offset:2560
    ds_read_b128 v[104:107], v9 offset:0
    ds_read_b128 v[108:111], v9 offset:32768
    s_waitcnt vmcnt(18)
    ds_write_b128 v240, v[160:163] offset:0
    ds_write_b128 v240, v[164:167] offset:1024
    s_waitcnt lgkmcnt(8)
    v_mfma_f32_32x32x16_bf16 v[16:31], v[80:83], v[88:91], v[16:31]
    v_mfma_f32_32x32x16_bf16 v[32:47], v[80:83], v[92:95], v[32:47]
    v_mfma_f32_32x32x16_bf16 v[48:63], v[84:87], v[88:91], v[48:63]
    v_mfma_f32_32x32x16_bf16 v[64:79], v[84:87], v[92:95], v[64:79]
    ds_read_b64_tr_b16 v[80:81], v12 offset:0
    ds_read_b64_tr_b16 v[82:83], v12 offset:512
    ds_read_b64_tr_b16 v[84:85], v13 offset:0
    ds_read_b64_tr_b16 v[86:87], v13 offset:512
    ds_read_b128 v[88:91], v10 offset:0
    ds_read_b128 v[92:95], v10 offset:32768
    s_waitcnt vmcnt(16)
    ds_write_b128 v240, v[168:171] offset:2048
    ds_write_b128 v240, v[172:175] offset:3072
    s_waitcnt lgkmcnt(8)
    v_mfma_f32_32x32x16_bf16 v[16:31], v[96:99], v[104:107], v[16:31]
    v_mfma_f32_32x32x16_bf16 v[32:47], v[96:99], v[108:111], v[32:47]
    v_mfma_f32_32x32x16_bf16 v[48:63], v[100:103], v[104:107], v[48:63]
    v_mfma_f32_32x32x16_bf16 v[64:79], v[100:103], v[108:111], v[64:79]
    ds_read_b64_tr_b16 v[96:97], v12 offset:2048
    ds_read_b64_tr_b16 v[98:99], v12 offset:2560
    ds_read_b64_tr_b16 v[100:101], v13 offset:2048
    ds_read_b64_tr_b16 v[102:103], v13 offset:2560
    ds_read_b128 v[104:107], v11 offset:0
    ds_read_b128 v[108:111], v11 offset:32768
    s_waitcnt vmcnt(14)
    ds_write_b128 v240, v[176:179] offset:0
    ds_write_b128 v240, v[180:183] offset:1024
    s_waitcnt lgkmcnt(8)
    v_mfma_f32_32x32x16_bf16 v[16:31], v[80:83], v[88:91], v[16:31]
    v_mfma_f32_32x32x16_bf16 v[32:47], v[80:83], v[92:95], v[32:47]
    v_mfma_f32_32x32x16_bf16 v[48:63], v[84:87], v[88:91], v[48:63]
    v_mfma_f32_32x32x16_bf16 v[64:79], v[84:87], v[92:95], v[64:79]
    v_xor_b32 v4, 0x100, v4
    v_xor_b32 v5, 0x100, v5
    v_xor_b32 v6, 0x100, v6
    v_xor_b32 v7, 0x100, v7
    v_xor_b32 v8, 0x100, v8
    v_xor_b32 v9, 0x100, v9
    v_xor_b32 v10, 0x100, v10
    v_xor_b32 v11, 0x100, v11
    ds_read_b64_tr_b16 v[80:81], v12 offset:0
    ds_read_b64_tr_b16 v[82:83], v12 offset:512
    ds_read_b64_tr_b16 v[84:85], v13 offset:0
    ds_read_b64_tr_b16 v[86:87], v13 offset:512
    ds_read_b128 v[88:91], v4 offset:0
    ds_read_b128 v[92:95], v4 offset:32768
    s_waitcnt vmcnt(12)
    ds_write_b128 v240, v[184:187] offset:2048
    ds_write_b128 v240, v[188:191] offset:3072
    s_waitcnt lgkmcnt(8)
    v_mfma_f32_32x32x16_bf16 v[16:31], v[96:99], v[104:107], v[16:31]
    v_mfma_f32_32x32x16_bf16 v[32:47], v[96:99], v[108:111], v[32:47]
    v_mfma_f32_32x32x16_bf16 v[48:63], v[100:103], v[104:107], v[48:63]
    v_mfma_f32_32x32x16_bf16 v[64:79], v[100:103], v[108:111], v[64:79]
    ds_read_b64_tr_b16 v[96:97], v12 offset:2048
    ds_read_b64_tr_b16 v[98:99], v12 offset:2560
    ds_read_b64_tr_b16 v[100:101], v13 offset:2048
    ds_read_b64_tr_b16 v[102:103], v13 offset:2560
    ds_read_b128 v[104:107], v5 offset:0
    ds_read_b128 v[108:111], v5 offset:32768
    s_waitcnt vmcnt(10)
    ds_write_b128 v240, v[192:195] offset:0
    ds_write_b128 v240, v[196:199] offset:1024
    s_waitcnt lgkmcnt(8)
    v_mfma_f32_32x32x16_bf16 v[16:31], v[80:83], v[88:91], v[16:31]
    v_mfma_f32_32x32x16_bf16 v[32:47], v[80:83], v[92:95], v[32:47]
    v_mfma_f32_32x32x16_bf16 v[48:63], v[84:87], v[88:91], v[48:63]
    v_mfma_f32_32x32x16_bf16 v[64:79], v[84:87], v[92:95], v[64:79]
    ds_read_b64_tr_b16 v[80:81], v12 offset:0
    ds_read_b64_tr_b16 v[82:83], v12 offset:512
    ds_read_b64_tr_b16 v[84:85], v13 offset:0
    ds_read_b64_tr_b16 v[86:87], v13 offset:512
    ds_read_b128 v[88:91], v6 offset:0
    ds_read_b128 v[92:95], v6 offset:32768
    s_waitcnt vmcnt(8)
    ds_write_b128 v240, v[200:203] offset:2048
    ds_write_b128 v240, v[204:207] offset:3072
    s_waitcnt lgkmcnt(8)
    v_mfma_f32_32x32x16_bf16 v[16:31], v[96:99], v[104:107], v[16:31]
    v_mfma_f32_32x32x16_bf16 v[32:47], v[96:99], v[108:111], v[32:47]
    v_mfma_f32_32x32x16_bf16 v[48:63], v[100:103], v[104:107], v[48:63]
    v_mfma_f32_32x32x16_bf16 v[64:79], v[100:103], v[108:111], v[64:79]
    ds_read_b64_tr_b16 v[96:97], v12 offset:2048
    ds_read_b64_tr_b16 v[98:99], v12 offset:2560
    ds_read_b64_tr_b16 v[100:101], v13 offset:2048
    ds_read_b64_tr_b16 v[102:103], v13 offset:2560
    ds_read_b128 v[104:107], v7 offset:0
    ds_read_b128 v[108:111], v7 offset:32768
    s_waitcnt vmcnt(6)
    ds_write_b128 v240, v[208:211] offset:0
    ds_write_b128 v240, v[212:215] offset:1024
    s_waitcnt lgkmcnt(8)
    v_mfma_f32_32x32x16_bf16 v[16:31], v[80:83], v[88:91], v[16:31]
    v_mfma_f32_32x32x16_bf16 v[32:47], v[80:83], v[92:95], v[32:47]
    v_mfma_f32_32x32x16_bf16 v[48:63], v[84:87], v[88:91], v[48:63]
    v_mfma_f32_32x32x16_bf16 v[64:79], v[84:87], v[92:95], v[64:79]
    ds_read_b64_tr_b16 v[80:81], v12 offset:0
    ds_read_b64_tr_b16 v[82:83], v12 offset:512
    ds_read_b64_tr_b16 v[84:85], v13 offset:0
    ds_read_b64_tr_b16 v[86:87], v13 offset:512
    ds_read_b128 v[88:91], v8 offset:0
    ds_read_b128 v[92:95], v8 offset:32768
    s_waitcnt vmcnt(4)
    ds_write_b128 v240, v[216:219] offset:2048
    ds_write_b128 v240, v[220:223] offset:3072
    s_waitcnt lgkmcnt(8)
    v_mfma_f32_32x32x16_bf16 v[16:31], v[96:99], v[104:107], v[16:31]
    v_mfma_f32_32x32x16_bf16 v[32:47], v[96:99], v[108:111], v[32:47]
    v_mfma_f32_32x32x16_bf16 v[48:63], v[100:103], v[104:107], v[48:63]
    v_mfma_f32_32x32x16_bf16 v[64:79], v[100:103], v[108:111], v[64:79]
    ds_read_b64_tr_b16 v[96:97], v12 offset:2048
    ds_read_b64_tr_b16 v[98:99], v12 offset:2560
    ds_read_b64_tr_b16 v[100:101], v13 offset:2048
    ds_read_b64_tr_b16 v[102:103], v13 offset:2560
    ds_read_b128 v[104:107], v9 offset:0
    ds_read_b128 v[108:111], v9 offset:32768
    s_waitcnt vmcnt(2)
    ds_write_b128 v240, v[224:227] offset:0
    ds_write_b128 v240, v[228:231] offset:1024
    s_waitcnt lgkmcnt(8)
    v_mfma_f32_32x32x16_bf16 v[16:31], v[80:83], v[88:91], v[16:31]
    v_mfma_f32_32x32x16_bf16 v[32:47], v[80:83], v[92:95], v[32:47]
    v_mfma_f32_32x32x16_bf16 v[48:63], v[84:87], v[88:91], v[48:63]
    v_mfma_f32_32x32x16_bf16 v[64:79], v[84:87], v[92:95], v[64:79]
    ds_read_b64_tr_b16 v[80:81], v12 offset:0
    ds_read_b64_tr_b16 v[82:83], v12 offset:512
    ds_read_b64_tr_b16 v[84:85], v13 offset:0
    ds_read_b64_tr_b16 v[86:87], v13 offset:512
    ds_read_b128 v[88:91], v10 offset:0
    ds_read_b128 v[92:95], v10 offset:32768
    s_waitcnt vmcnt(0)
    ds_write_b128 v240, v[232:235] offset:2048
    ds_write_b128 v240, v[236:239] offset:3072
    s_waitcnt lgkmcnt(8)
    v_mfma_f32_32x32x16_bf16 v[16:31], v[96:99], v[104:107], v[16:31]
    v_mfma_f32_32x32x16_bf16 v[32:47], v[96:99], v[108:111], v[32:47]
    v_mfma_f32_32x32x16_bf16 v[48:63], v[100:103], v[104:107], v[48:63]
    v_mfma_f32_32x32x16_bf16 v[64:79], v[100:103], v[108:111], v[64:79]
    s_add_u32 s53, s42, 0
    buffer_load_dwordx4 v[112:115], v3, s[36:39], s53 offen
    s_add_u32 s53, s42, 28672
    buffer_load_dwordx4 v[116:119], v3, s[36:39], s53 offen
    s_add_u32 s53, s42, 57344
    buffer_load_dwordx4 v[120:123], v3, s[36:39], s53 offen
    s_add_u32 s53, s42, 86016
    buffer_load_dwordx4 v[124:127], v3, s[36:39], s53 offen
    s_add_u32 s53, s42, 114688
    buffer_load_dwordx4 v[128:131], v3, s[36:39], s53 offen
    s_add_u32 s53, s42, 143360
    buffer_load_dwordx4 v[132:135], v3, s[36:39], s53 offen
    s_add_u32 s53, s42, 172032
    buffer_load_dwordx4 v[136:139], v3, s[36:39], s53 offen
    s_add_u32 s53, s42, 200704
    buffer_load_dwordx4 v[140:143], v3, s[36:39], s53 offen
    s_add_u32 s53, s42, 229376
    buffer_load_dwordx4 v[144:147], v3, s[36:39], s53 offen
    s_add_u32 s53, s42, 258048
    buffer_load_dwordx4 v[148:151], v3, s[36:39], s53 offen
    s_add_u32 s53, s42, 286720
    buffer_load_dwordx4 v[152:155], v3, s[36:39], s53 offen
    s_add_u32 s53, s42, 315392
    buffer_load_dwordx4 v[156:159], v3, s[36:39], s53 offen
    s_add_u32 s53, s42, 344064
    buffer_load_dwordx4 v[160:163], v3, s[36:39], s53 offen
    s_add_u32 s53, s42, 372736
    buffer_load_dwordx4 v[164:167], v3, s[36:39], s53 offen
    s_add_u32 s53, s42, 401408
    buffer_load_dwordx4 v[168:171], v3, s[36:39], s53 offen
    s_add_u32 s53, s42, 430080
    buffer_load_dwordx4 v[172:175], v3, s[36:39], s53 offen
    ds_read_b64_tr_b16 v[96:97], v12 offset:2048
    ds_read_b64_tr_b16 v[98:99], v12 offset:2560
    ds_read_b64_tr_b16 v[100:101], v13 offset:2048
    ds_read_b64_tr_b16 v[102:103], v13 offset:2560
    ds_read_b128 v[104:107], v11 offset:0
    ds_read_b128 v[108:111], v11 offset:32768
    s_waitcnt vmcnt(14)
    ds_write_b128 v240, v[112:115] offset:0
    ds_write_b128 v240, v[116:119] offset:1024
    s_add_u32 s53, s43, 0
    buffer_load_dwordx4 v[176:179], v3, s[36:39], s53 offen
    s_add_u32 s53, s43, 28672
    buffer_load_dwordx4 v[180:183], v3, s[36:39], s53 offen
    s_waitcnt lgkmcnt(8)
    v_mfma_f32_32x32x16_bf16 v[16:31], v[80:83], v[88:91], v[16:31]
    v_mfma_f32_32x32x16_bf16 v[32:47], v[80:83], v[92:95], v[32:47]
    v_mfma_f32_32x32x16_bf16 v[48:63], v[84:87], v[88:91], v[48:63]
    v_mfma_f32_32x32x16_bf16 v[64:79], v[84:87], v[92:95], v[64:79]
    v_xor_b32 v4, 0x300, v4
    v_xor_b32 v5, 0x300, v5
    v_xor_b32 v6, 0x300, v6
    v_xor_b32 v7, 0x300, v7
    v_xor_b32 v8, 0x300, v8
    v_xor_b32 v9, 0x300, v9
    v_xor_b32 v10, 0x300, v10
    v_xor_b32 v11, 0x300, v11
    ds_read_b64_tr_b16 v[80:81], v12 offset:0
    ds_read_b64_tr_b16 v[82:83], v12 offset:512
    ds_read_b64_tr_b16 v[84:85], v13 offset:0
    ds_read_b64_tr_b16 v[86:87], v13 offset:512
    ds_read_b128 v[88:91], v4 offset:0
    ds_read_b128 v[92:95], v4 offset:32768
    s_waitcnt vmcnt(14)
    ds_write_b128 v240, v[120:123] offset:2048
    ds_write_b128 v240, v[124:127] offset:3072
    s_add_u32 s53, s43, 57344
    buffer_load_dwordx4 v[184:187], v3, s[36:39], s53 offen
    s_add_u32 s53, s43, 86016
    buffer_load_dwordx4 v[188:191], v3, s[36:39], s53 offen
    s_waitcnt lgkmcnt(8)
    v_mfma_f32_32x32x16_bf16 v[16:31], v[96:99], v[104:107], v[16:31]
    v_mfma_f32_32x32x16_bf16 v[32:47], v[96:99], v[108:111], v[32:47]
    v_mfma_f32_32x32x16_bf16 v[48:63], v[100:103], v[104:107], v[48:63]
    v_mfma_f32_32x32x16_bf16 v[64:79], v[100:103], v[108:111], v[64:79]
    ds_read_b64_tr_b16 v[96:97], v12 offset:2048
    ds_read_b64_tr_b16 v[98:99], v12 offset:2560
    ds_read_b64_tr_b16 v[100:101], v13 offset:2048
    ds_read_b64_tr_b16 v[102:103], v13 offset:2560
    ds_read_b128 v[104:107], v5 offset:0
    ds_read_b128 v[108:111], v5 offset:32768
    s_waitcnt vmcnt(14)
    ds_write_b128 v240, v[128:131] offset:0
    ds_write_b128 v240, v[132:135] offset:1024
    s_add_u32 s53, s43, 114688
    buffer_load_dwordx4 v[192:195], v3, s[36:39], s53 offen
    s_add_u32 s53, s43, 143360
    buffer_load_dwordx4 v[196:199], v3, s[36:39], s53 offen
    s_waitcnt lgkmcnt(8)
    v_mfma_f32_32x32x16_bf16 v[16:31], v[80:83], v[88:91], v[16:31]
    v_mfma_f32_32x32x16_bf16 v[32:47], v[80:83], v[92:95], v[32:47]
    v_mfma_f32_32x32x16_bf16 v[48:63], v[84:87], v[88:91], v[48:63]
    v_mfma_f32_32x32x16_bf16 v[64:79], v[84:87], v[92:95], v[64:79]
    ds_read_b64_tr_b16 v[80:81], v12 offset:0
    ds_read_b64_tr_b16 v[82:83], v12 offset:512
    ds_read_b64_tr_b16 v[84:85], v13 offset:0
    ds_read_b64_tr_b16 v[86:87], v13 offset:512
    ds_read_b128 v[88:91], v6 offset:0
    ds_read_b128 v[92:95], v6 offset:32768
    s_waitcnt vmcnt(14)
    ds_write_b128 v240, v[136:139] offset:2048
    ds_write_b128 v240, v[140:143] offset:3072
    s_add_u32 s53, s43, 172032
    buffer_load_dwordx4 v[200:203], v3, s[36:39], s53 offen
    s_add_u32 s53, s43, 200704
    buffer_load_dwordx4 v[204:207], v3, s[36:39], s53 offen
    s_waitcnt lgkmcnt(8)
    v_mfma_f32_32x32x16_bf16 v[16:31], v[96:99], v[104:107], v[16:31]
    v_mfma_f32_32x32x16_bf16 v[32:47], v[96:99], v[108:111], v[32:47]
    v_mfma_f32_32x32x16_bf16 v[48:63], v[100:103], v[104:107], v[48:63]
    v_mfma_f32_32x32x16_bf16 v[64:79], v[100:103], v[108:111], v[64:79]
    ds_read_b64_tr_b16 v[96:97], v12 offset:2048
    ds_read_b64_tr_b16 v[98:99], v12 offset:2560
    ds_read_b64_tr_b16 v[100:101], v13 offset:2048
    ds_read_b64_tr_b16 v[102:103], v13 offset:2560
    ds_read_b128 v[104:107], v7 offset:0
    ds_read_b128 v[108:111], v7 offset:32768
    s_waitcnt vmcnt(14)
    ds_write_b128 v240, v[144:147] offset:0
    ds_write_b128 v240, v[148:151] offset:1024
    s_add_u32 s53, s43, 229376
    buffer_load_dwordx4 v[208:211], v3, s[36:39], s53 offen
    s_add_u32 s53, s43, 258048
    buffer_load_dwordx4 v[212:215], v3, s[36:39], s53 offen
    s_waitcnt lgkmcnt(8)
    v_mfma_f32_32x32x16_bf16 v[16:31], v[80:83], v[88:91], v[16:31]
    v_mfma_f32_32x32x16_bf16 v[32:47], v[80:83], v[92:95], v[32:47]
    v_mfma_f32_32x32x16_bf16 v[48:63], v[84:87], v[88:91], v[48:63]
    v_mfma_f32_32x32x16_bf16 v[64:79], v[84:87], v[92:95], v[64:79]
    ds_read_b64_tr_b16 v[80:81], v12 offset:0
    ds_read_b64_tr_b16 v[82:83], v12 offset:512
    ds_read_b64_tr_b16 v[84:85], v13 offset:0
    ds_read_b64_tr_b16 v[86:87], v13 offset:512
    ds_read_b128 v[88:91], v8 offset:0
    ds_read_b128 v[92:95], v8 offset:32768
    s_waitcnt vmcnt(14)
    ds_write_b128 v240, v[152:155] offset:2048
    ds_write_b128 v240, v[156:159] offset:3072
    s_add_u32 s53, s43, 286720
    buffer_load_dwordx4 v[216:219], v3, s[36:39], s53 offen
    s_add_u32 s53, s43, 315392
    buffer_load_dwordx4 v[220:223], v3, s[36:39], s53 offen
    s_waitcnt lgkmcnt(8)
    v_mfma_f32_32x32x16_bf16 v[16:31], v[96:99], v[104:107], v[16:31]
    v_mfma_f32_32x32x16_bf16 v[32:47], v[96:99], v[108:111], v[32:47]
    v_mfma_f32_32x32x16_bf16 v[48:63], v[100:103], v[104:107], v[48:63]
    v_mfma_f32_32x32x16_bf16 v[64:79], v[100:103], v[108:111], v[64:79]
    ds_read_b64_tr_b16 v[96:97], v12 offset:2048
    ds_read_b64_tr_b16 v[98:99], v12 offset:2560
    ds_read_b64_tr_b16 v[100:101], v13 offset:2048
    ds_read_b64_tr_b16 v[102:103], v13 offset:2560
    ds_read_b128 v[104:107], v9 offset:0
    ds_read_b128 v[108:111], v9 offset:32768
    s_waitcnt vmcnt(14)
    ds_write_b128 v240, v[160:163] offset:0
    ds_write_b128 v240, v[164:167] offset:1024
    s_add_u32 s53, s43, 344064
    buffer_load_dwordx4 v[224:227], v3, s[36:39], s53 offen
    s_add_u32 s53, s43, 372736
    buffer_load_dwordx4 v[228:231], v3, s[36:39], s53 offen
    s_waitcnt lgkmcnt(8)
    v_mfma_f32_32x32x16_bf16 v[16:31], v[80:83], v[88:91], v[16:31]
    v_mfma_f32_32x32x16_bf16 v[32:47], v[80:83], v[92:95], v[32:47]
    v_mfma_f32_32x32x16_bf16 v[48:63], v[84:87], v[88:91], v[48:63]
    v_mfma_f32_32x32x16_bf16 v[64:79], v[84:87], v[92:95], v[64:79]
    ds_read_b64_tr_b16 v[80:81], v12 offset:0
    ds_read_b64_tr_b16 v[82:83], v12 offset:512
    ds_read_b64_tr_b16 v[84:85], v13 offset:0
    ds_read_b64_tr_b16 v[86:87], v13 offset:512
    ds_read_b128 v[88:91], v10 offset:0
    ds_read_b128 v[92:95], v10 offset:32768
    s_waitcnt vmcnt(14)
    ds_write_b128 v240, v[168:171] offset:2048
    ds_write_b128 v240, v[172:175] offset:3072
    s_add_u32 s53, s43, 401408
    buffer_load_dwordx4 v[232:235], v3, s[36:39], s53 offen
    s_add_u32 s53, s43, 430080
    buffer_load_dwordx4 v[236:239], v3, s[36:39], s53 offen
    s_waitcnt lgkmcnt(8)
    v_mfma_f32_32x32x16_bf16 v[16:31], v[96:99], v[104:107], v[16:31]
    v_mfma_f32_32x32x16_bf16 v[32:47], v[96:99], v[108:111], v[32:47]
    v_mfma_f32_32x32x16_bf16 v[48:63], v[100:103], v[104:107], v[48:63]
    v_mfma_f32_32x32x16_bf16 v[64:79], v[100:103], v[108:111], v[64:79]
    ds_read_b64_tr_b16 v[96:97], v12 offset:2048
    ds_read_b64_tr_b16 v[98:99], v12 offset:2560
    ds_read_b64_tr_b16 v[100:101], v13 offset:2048
    ds_read_b64_tr_b16 v[102:103], v13 offset:2560
    ds_read_b128 v[104:107], v11 offset:0
    ds_read_b128 v[108:111], v11 offset:32768
    s_waitcnt vmcnt(14)
    ds_write_b128 v240, v[176:179] offset:0
    ds_write_b128 v240, v[180:183] offset:1024
    s_waitcnt lgkmcnt(8)
    v_mfma_f32_32x32x16_bf16 v[16:31], v[80:83], v[88:91], v[16:31]
    v_mfma_f32_32x32x16_bf16 v[32:47], v[80:83], v[92:95], v[32:47]
    v_mfma_f32_32x32x16_bf16 v[48:63], v[84:87], v[88:91], v[48:63]
    v_mfma_f32_32x32x16_bf16 v[64:79], v[84:87], v[92:95], v[64:79]
    v_xor_b32 v4, 0x100, v4
    v_xor_b32 v5, 0x100, v5
    v_xor_b32 v6, 0x100, v6
    v_xor_b32 v7, 0x100, v7
    v_xor_b32 v8, 0x100, v8
    v_xor_b32 v9, 0x100, v9
    v_xor_b32 v10, 0x100, v10
    v_xor_b32 v11, 0x100, v11
    ds_read_b64_tr_b16 v[80:81], v12 offset:0
    ds_read_b64_tr_b16 v[82:83], v12 offset:512
    ds_read_b64_tr_b16 v[84:85], v13 offset:0
    ds_read_b64_tr_b16 v[86:87], v13 offset:512
    ds_read_b128 v[88:91], v4 offset:0
    ds_read_b128 v[92:95], v4 offset:32768
    s_waitcnt vmcnt(12)
    ds_write_b128 v240, v[184:187] offset:2048
    ds_write_b128 v240, v[188:191] offset:3072
    s_waitcnt lgkmcnt(8)
    v_mfma_f32_32x32x16_bf16 v[16:31], v[96:99], v[104:107], v[16:31]
    v_mfma_f32_32x32x16_bf16 v[32:47], v[96:99], v[108:111], v[32:47]
    v_mfma_f32_32x32x16_bf16 v[48:63], v[100:103], v[104:107], v[48:63]
    v_mfma_f32_32x32x16_bf16 v[64:79], v[100:103], v[108:111], v[64:79]
    ds_read_b64_tr_b16 v[96:97], v12 offset:2048
    ds_read_b64_tr_b16 v[98:99], v12 offset:2560
    ds_read_b64_tr_b16 v[100:101], v13 offset:2048
    ds_read_b64_tr_b16 v[102:103], v13 offset:2560
    ds_read_b128 v[104:107], v5 offset:0
    ds_read_b128 v[108:111], v5 offset:32768
    s_waitcnt vmcnt(10)
    ds_write_b128 v240, v[192:195] offset:0
    ds_write_b128 v240, v[196:199] offset:1024
    s_waitcnt lgkmcnt(8)
    v_mfma_f32_32x32x16_bf16 v[16:31], v[80:83], v[88:91], v[16:31]
    v_mfma_f32_32x32x16_bf16 v[32:47], v[80:83], v[92:95], v[32:47]
    v_mfma_f32_32x32x16_bf16 v[48:63], v[84:87], v[88:91], v[48:63]
    v_mfma_f32_32x32x16_bf16 v[64:79], v[84:87], v[92:95], v[64:79]
    ds_read_b64_tr_b16 v[80:81], v12 offset:0
    ds_read_b64_tr_b16 v[82:83], v12 offset:512
    ds_read_b64_tr_b16 v[84:85], v13 offset:0
    ds_read_b64_tr_b16 v[86:87], v13 offset:512
    ds_read_b128 v[88:91], v6 offset:0
    ds_read_b128 v[92:95], v6 offset:32768
    s_waitcnt vmcnt(8)
    ds_write_b128 v240, v[200:203] offset:2048
    ds_write_b128 v240, v[204:207] offset:3072
    s_waitcnt lgkmcnt(8)
    v_mfma_f32_32x32x16_bf16 v[16:31], v[96:99], v[104:107], v[16:31]
    v_mfma_f32_32x32x16_bf16 v[32:47], v[96:99], v[108:111], v[32:47]
    v_mfma_f32_32x32x16_bf16 v[48:63], v[100:103], v[104:107], v[48:63]
    v_mfma_f32_32x32x16_bf16 v[64:79], v[100:103], v[108:111], v[64:79]
    ds_read_b64_tr_b16 v[96:97], v12 offset:2048
    ds_read_b64_tr_b16 v[98:99], v12 offset:2560
    ds_read_b64_tr_b16 v[100:101], v13 offset:2048
    ds_read_b64_tr_b16 v[102:103], v13 offset:2560
    ds_read_b128 v[104:107], v7 offset:0
    ds_read_b128 v[108:111], v7 offset:32768
    s_waitcnt vmcnt(6)
    ds_write_b128 v240, v[208:211] offset:0
    ds_write_b128 v240, v[212:215] offset:1024
    s_waitcnt lgkmcnt(8)
    v_mfma_f32_32x32x16_bf16 v[16:31], v[80:83], v[88:91], v[16:31]
    v_mfma_f32_32x32x16_bf16 v[32:47], v[80:83], v[92:95], v[32:47]
    v_mfma_f32_32x32x16_bf16 v[48:63], v[84:87], v[88:91], v[48:63]
    v_mfma_f32_32x32x16_bf16 v[64:79], v[84:87], v[92:95], v[64:79]
    ds_read_b64_tr_b16 v[80:81], v12 offset:0
    ds_read_b64_tr_b16 v[82:83], v12 offset:512
    ds_read_b64_tr_b16 v[84:85], v13 offset:0
    ds_read_b64_tr_b16 v[86:87], v13 offset:512
    ds_read_b128 v[88:91], v8 offset:0
    ds_read_b128 v[92:95], v8 offset:32768
    s_waitcnt vmcnt(4)
    ds_write_b128 v240, v[216:219] offset:2048
    ds_write_b128 v240, v[220:223] offset:3072
    s_waitcnt lgkmcnt(8)
    v_mfma_f32_32x32x16_bf16 v[16:31], v[96:99], v[104:107], v[16:31]
    v_mfma_f32_32x32x16_bf16 v[32:47], v[96:99], v[108:111], v[32:47]
    v_mfma_f32_32x32x16_bf16 v[48:63], v[100:103], v[104:107], v[48:63]
    v_mfma_f32_32x32x16_bf16 v[64:79], v[100:103], v[108:111], v[64:79]
    ds_read_b64_tr_b16 v[96:97], v12 offset:2048
    ds_read_b64_tr_b16 v[98:99], v12 offset:2560
    ds_read_b64_tr_b16 v[100:101], v13 offset:2048
    ds_read_b64_tr_b16 v[102:103], v13 offset:2560
    ds_read_b128 v[104:107], v9 offset:0
    ds_read_b128 v[108:111], v9 offset:32768
    s_waitcnt vmcnt(2)
    ds_write_b128 v240, v[224:227] offset:0
    ds_write_b128 v240, v[228:231] offset:1024
    s_waitcnt lgkmcnt(8)
    v_mfma_f32_32x32x16_bf16 v[16:31], v[80:83], v[88:91], v[16:31]
    v_mfma_f32_32x32x16_bf16 v[32:47], v[80:83], v[92:95], v[32:47]
    v_mfma_f32_32x32x16_bf16 v[48:63], v[84:87], v[88:91], v[48:63]
    v_mfma_f32_32x32x16_bf16 v[64:79], v[84:87], v[92:95], v[64:79]
    ds_read_b64_tr_b16 v[80:81], v12 offset:0
    ds_read_b64_tr_b16 v[82:83], v12 offset:512
    ds_read_b64_tr_b16 v[84:85], v13 offset:0
    ds_read_b64_tr_b16 v[86:87], v13 offset:512
    ds_read_b128 v[88:91], v10 offset:0
    ds_read_b128 v[92:95], v10 offset:32768
    s_waitcnt vmcnt(0)
    ds_write_b128 v240, v[232:235] offset:2048
    ds_write_b128 v240, v[236:239] offset:3072
    s_waitcnt lgkmcnt(8)
    v_mfma_f32_32x32x16_bf16 v[16:31], v[96:99], v[104:107], v[16:31]
    v_mfma_f32_32x32x16_bf16 v[32:47], v[96:99], v[108:111], v[32:47]
    v_mfma_f32_32x32x16_bf16 v[48:63], v[100:103], v[104:107], v[48:63]
    v_mfma_f32_32x32x16_bf16 v[64:79], v[100:103], v[108:111], v[64:79]
    ds_read_b64_tr_b16 v[96:97], v12 offset:2048
    ds_read_b64_tr_b16 v[98:99], v12 offset:2560
    ds_read_b64_tr_b16 v[100:101], v13 offset:2048
    ds_read_b64_tr_b16 v[102:103], v13 offset:2560
    ds_read_b128 v[104:107], v11 offset:0
    ds_read_b128 v[108:111], v11 offset:32768
    s_waitcnt lgkmcnt(6)
    v_mfma_f32_32x32x16_bf16 v[16:31], v[80:83], v[88:91], v[16:31]
    v_mfma_f32_32x32x16_bf16 v[32:47], v[80:83], v[92:95], v[32:47]
    v_mfma_f32_32x32x16_bf16 v[48:63], v[84:87], v[88:91], v[48:63]
    v_mfma_f32_32x32x16_bf16 v[64:79], v[84:87], v[92:95], v[64:79]
    s_waitcnt lgkmcnt(0)
    v_mfma_f32_32x32x16_bf16 v[16:31], v[96:99], v[104:107], v[16:31]
    v_mfma_f32_32x32x16_bf16 v[32:47], v[96:99], v[108:111], v[32:47]
    v_mfma_f32_32x32x16_bf16 v[48:63], v[100:103], v[104:107], v[48:63]
    v_mfma_f32_32x32x16_bf16 v[64:79], v[100:103], v[108:111], v[64:79]
    v_mov_b32 v14, 162064
    v_mov_b32 v15, 1
    s_mov_b64 exec, 1
    ds_add_u32 v14, v15
    s_mov_b64 exec, -1
    s_setprio 3
    s_lshl_b32 s52, s4, 1
    s_mul_i32 s52, s52, 112
    s_lshl_b32 s53, s5, 4
    s_add_u32 s52, s52, s53
    s_lshl_b32 s53, s6, 2
    s_add_u32 s52, s52, s53
    s_lshl_b32 s52, s52, 10
    s_add_u32 s55, s52, 4194304
    s_add_u32 s56, s55, 114688
    s_nop 7
    v_cvt_pk_bf16_f32 v80, v16, v17
    v_cvt_pk_bf16_f32 v81, v18, v19
    v_cvt_pk_bf16_f32 v82, v20, v21
    v_cvt_pk_bf16_f32 v83, v22, v23
    v_cvt_pk_bf16_f32 v84, v24, v25
    v_cvt_pk_bf16_f32 v85, v26, v27
    v_cvt_pk_bf16_f32 v86, v28, v29
    v_cvt_pk_bf16_f32 v87, v30, v31
    v_pk_max_i16 v80, v80, 0
    v_pk_max_i16 v81, v81, 0
    v_pk_max_i16 v82, v82, 0
    v_pk_max_i16 v83, v83, 0
    v_pk_max_i16 v84, v84, 0
    v_pk_max_i16 v85, v85, 0
    v_pk_max_i16 v86, v86, 0
    v_pk_max_i16 v87, v87, 0
    buffer_store_dwordx4 v[80:83], v2, s[44:47], s55 offen offset:0 sc1
    buffer_store_dwordx4 v[84:87], v2, s[44:47], s55 offen offset:1024 sc1
    v_cvt_pk_bf16_f32 v88, v32, v33
    v_cvt_pk_bf16_f32 v89, v34, v35
    v_cvt_pk_bf16_f32 v90, v36, v37
    v_cvt_pk_bf16_f32 v91, v38, v39
    v_cvt_pk_bf16_f32 v92, v40, v41
    v_cvt_pk_bf16_f32 v93, v42, v43
    v_cvt_pk_bf16_f32 v94, v44, v45
    v_cvt_pk_bf16_f32 v95, v46, v47
    v_pk_max_i16 v88, v88, 0
    v_pk_max_i16 v89, v89, 0
    v_pk_max_i16 v90, v90, 0
    v_pk_max_i16 v91, v91, 0
    v_pk_max_i16 v92, v92, 0
    v_pk_max_i16 v93, v93, 0
    v_pk_max_i16 v94, v94, 0
    v_pk_max_i16 v95, v95, 0
    buffer_store_dwordx4 v[88:91], v2, s[44:47], s56 offen offset:0 sc1
    buffer_store_dwordx4 v[92:95], v2, s[44:47], s56 offen offset:1024 sc1
    v_cvt_pk_bf16_f32 v96, v48, v49
    v_cvt_pk_bf16_f32 v97, v50, v51
    v_cvt_pk_bf16_f32 v98, v52, v53
    v_cvt_pk_bf16_f32 v99, v54, v55
    v_cvt_pk_bf16_f32 v100, v56, v57
    v_cvt_pk_bf16_f32 v101, v58, v59
    v_cvt_pk_bf16_f32 v102, v60, v61
    v_cvt_pk_bf16_f32 v103, v62, v63
    v_pk_max_i16 v96, v96, 0
    v_pk_max_i16 v97, v97, 0
    v_pk_max_i16 v98, v98, 0
    v_pk_max_i16 v99, v99, 0
    v_pk_max_i16 v100, v100, 0
    v_pk_max_i16 v101, v101, 0
    v_pk_max_i16 v102, v102, 0
    v_pk_max_i16 v103, v103, 0
    buffer_store_dwordx4 v[96:99], v2, s[44:47], s55 offen offset:2048 sc1
    buffer_store_dwordx4 v[100:103], v2, s[44:47], s55 offen offset:3072 sc1
    v_cvt_pk_bf16_f32 v104, v64, v65
    v_cvt_pk_bf16_f32 v105, v66, v67
    v_cvt_pk_bf16_f32 v106, v68, v69
    v_cvt_pk_bf16_f32 v107, v70, v71
    v_cvt_pk_bf16_f32 v108, v72, v73
    v_cvt_pk_bf16_f32 v109, v74, v75
    v_cvt_pk_bf16_f32 v110, v76, v77
    v_cvt_pk_bf16_f32 v111, v78, v79
    v_pk_max_i16 v104, v104, 0
    v_pk_max_i16 v105, v105, 0
    v_pk_max_i16 v106, v106, 0
    v_pk_max_i16 v107, v107, 0
    v_pk_max_i16 v108, v108, 0
    v_pk_max_i16 v109, v109, 0
    v_pk_max_i16 v110, v110, 0
    v_pk_max_i16 v111, v111, 0
    buffer_store_dwordx4 v[104:107], v2, s[44:47], s56 offen offset:2048 sc1
    buffer_store_dwordx4 v[108:111], v2, s[44:47], s56 offen offset:3072 sc1
    s_setprio 1
    s_mov_b32 s36, s22
    s_mov_b32 s37, s23
    s_mov_b32 s38, 0x1c0000
    s_mov_b32 s39, 0x00020000
    s_mov_b32 s40, s16
    s_mov_b32 s41, s17
    s_mov_b32 s42, 0x80000
    s_mov_b32 s43, 0x00020000
    v_lshrrev_b32 v14, 3, v1
    v_mul_u32_u24 v14, 1024, v14
    v_and_b32 v15, 7, v1
    v_bfe_u32 v3, v1, 4, 1
    v_lshlrev_b32 v3, 2, v3
    v_xor_b32 v15, v15, v3
    v_lshl_add_u32 v3, v15, 4, v14
    s_mul_i32 s50, s6, 20480
    s_add_u32 s50, s50, 0
    s_lshl_b32 s52, s5, 7
    s_mul_i32 s54, s6, 458752
    s_add_u32 s54, s54, s52
    s_lshl_b32 s57, s6, 17
    s_add_u32 s57, s57, s52
    v_lshrrev_b32 v14, 5, v1
    v_bfe_u32 v15, v1, 2, 2
    v_lshl_add_u32 v14, v14, 2, v15
    v_lshlrev_b32 v14, 7, v14
    v_lshrrev_b32 v15, 1, v15
    v_lshl_add_u32 v14, v15, 6, v14
    v_bfe_u32 v15, v1, 4, 1
    v_lshl_add_u32 v14, v15, 5, v14
    v_and_b32 v15, 3, v1
    v_lshl_add_u32 v14, v15, 3, v14
    v_add_u32 v12, s50, v14
    v_xor_b32 v13, 64, v12
    s_and_b32 s8, s4, 7
    s_mul_i32 s8, s8, 2
    s_and_b32 s9, s5, 3
    s_mul_i32 s9, s9, 4
    s_add_u32 s8, s8, s9
    s_sub_u32 s9, s8, 14
    s_cmp_ge_u32 s8, 14
    s_cselect_b32 s8, s9, s8
    s_sub_u32 s9, s8, 14
    s_cmp_ge_u32 s8, 14
    s_cselect_b32 s8, s9, s8
    s_lshl_b32 s10, s8, 11
    s_lshl_b32 s8, s8, 15
    s_add_u32 s8, s8, s54
    s_add_u32 s9, s54, 458752
    s_waitcnt vmcnt(0)
    v_mov_b32 v14, 162060
    v_mov_b32 v15, 1
    s_mov_b64 exec, 1
    ds_add_rtn_u32 v15, v14, v15
    s_mov_b64 exec, -1
    s_waitcnt lgkmcnt(0)
    v_readfirstlane_b32 s52, v15
    s_cmp_lg_u32 s52, 3
    s_cbranch_scc1 G_hfd
    v_mov_b32 v14, 162112
lw_9:
    ds_read_b32 v15, v14
    s_waitcnt lgkmcnt(0)
    v_readfirstlane_b32 s52, v15
    s_cmp_ge_u32 s52, 1
    s_cbranch_scc1 lw_9_d
    s_sleep 1
    s_add_u32 s58, s58, 1
    s_cmp_lt_u32 s58, 200000
    s_cbranch_scc1 lw_9
lw_9_d:
    s_lshl_b32 s52, s4, 11
    s_lshl_b32 s53, s5, 7
    s_add_u32 s52, s52, s53
    s_add_u32 s52, s52, 2293760
    v_mov_b32 v14, 0
    v_mov_b32 v15, 1
    s_mov_b64 exec, 1
    buffer_store_dword v15, v14, s[44:47], s52 offen sc1
    s_mov_b64 exec, -1
G_hfd:
    v_mov_b32 v14, 162064
lw_10:
    ds_read_b32 v15, v14
    s_waitcnt lgkmcnt(0)
    v_readfirstlane_b32 s52, v15
    s_cmp_ge_u32 s52, 4
    s_cbranch_scc1 lw_10_d
    s_sleep 1
    s_add_u32 s58, s58, 1
    s_cmp_lt_u32 s58, 200000
    s_cbranch_scc1 lw_10
lw_10_d:
    v_mov_b32 v14, 162052
lw_11:
    ds_read_b32 v15, v14
    s_waitcnt lgkmcnt(0)
    v_readfirstlane_b32 s52, v15
    s_cmp_ge_u32 s52, 4
    s_cbranch_scc1 lw_11_d
    s_sleep 1
    s_add_u32 s58, s58, 1
    s_cmp_lt_u32 s58, 200000
    s_cbranch_scc1 lw_11
lw_11_d:
    v_mov_b32 v14, 162084
lw_12:
    ds_read_b32 v15, v14
    s_waitcnt lgkmcnt(0)
    v_readfirstlane_b32 s52, v15
    s_cmp_ge_u32 s52, 2
    s_cbranch_scc1 lw_12_d
    s_sleep 1
    s_add_u32 s58, s58, 1
    s_cmp_lt_u32 s58, 200000
    s_cbranch_scc1 lw_12
lw_12_d:
    s_add_u32 s52, s50, 0
    s_add_u32 s53, s8, 0
    s_mov_b32 m0, s52
    s_nop 0
    buffer_load_dwordx4 v3, s[36:39], s53 offen lds
    s_add_u32 s52, s50, 1024
    s_add_u32 s53, s8, 8192
    s_mov_b32 m0, s52
    s_nop 0
    buffer_load_dwordx4 v3, s[36:39], s53 offen lds
    s_add_u32 s52, s50, 2048
    s_add_u32 s53, s8, 16384
    s_mov_b32 m0, s52
    s_nop 0
    buffer_load_dwordx4 v3, s[36:39], s53 offen lds
    s_add_u32 s52, s50, 3072
    s_add_u32 s53, s8, 24576
    s_mov_b32 m0, s52
    s_nop 0
    buffer_load_dwordx4 v3, s[36:39], s53 offen lds
    s_add_u32 s8, s8, 32768
    s_cmp_eq_u32 s8, s9
    s_cselect_b32 s8, s54, s8
    s_add_u32 s52, s50, 4096
    s_add_u32 s53, s8, 0
    s_mov_b32 m0, s52
    s_nop 0
    buffer_load_dwordx4 v3, s[36:39], s53 offen lds
    s_add_u32 s52, s50, 5120
    s_add_u32 s53, s8, 8192
    s_mov_b32 m0, s52
    s_nop 0
    buffer_load_dwordx4 v3, s[36:39], s53 offen lds
    s_add_u32 s52, s50, 6144
    s_add_u32 s53, s8, 16384
    s_mov_b32 m0, s52
    s_nop 0
    buffer_load_dwordx4 v3, s[36:39], s53 offen lds
    s_add_u32 s52, s50, 7168
    s_add_u32 s53, s8, 24576
    s_mov_b32 m0, s52
    s_nop 0
    buffer_load_dwordx4 v3, s[36:39], s53 offen lds
    s_add_u32 s8, s8, 32768
    s_cmp_eq_u32 s8, s9
    s_cselect_b32 s8, s54, s8
    s_add_u32 s52, s50, 8192
    s_add_u32 s53, s8, 0
    s_mov_b32 m0, s52
    s_nop 0
    buffer_load_dwordx4 v3, s[36:39], s53 offen lds
    s_add_u32 s52, s50, 9216
    s_add_u32 s53, s8, 8192
    s_mov_b32 m0, s52
    s_nop 0
    buffer_load_dwordx4 v3, s[36:39], s53 offen lds
    s_add_u32 s52, s50, 10240
    s_add_u32 s53, s8, 16384
    s_mov_b32 m0, s52
    s_nop 0
    buffer_load_dwordx4 v3, s[36:39], s53 offen lds
    s_add_u32 s52, s50, 11264
    s_add_u32 s53, s8, 24576
    s_mov_b32 m0, s52
    s_nop 0
    buffer_load_dwordx4 v3, s[36:39], s53 offen lds
    s_add_u32 s8, s8, 32768
    s_cmp_eq_u32 s8, s9
    s_cselect_b32 s8, s54, s8
    s_add_u32 s52, s50, 12288
    s_add_u32 s53, s8, 0
    s_mov_b32 m0, s52
    s_nop 0
    buffer_load_dwordx4 v3, s[36:39], s53 offen lds
    s_add_u32 s52, s50, 13312
    s_add_u32 s53, s8, 8192
    s_mov_b32 m0, s52
    s_nop 0
    buffer_load_dwordx4 v3, s[36:39], s53 offen lds
    s_add_u32 s52, s50, 14336
    s_add_u32 s53, s8, 16384
    s_mov_b32 m0, s52
    s_nop 0
    buffer_load_dwordx4 v3, s[36:39], s53 offen lds
    s_add_u32 s52, s50, 15360
    s_add_u32 s53, s8, 24576
    s_mov_b32 m0, s52
    s_nop 0
    buffer_load_dwordx4 v3, s[36:39], s53 offen lds
    s_add_u32 s8, s8, 32768
    s_cmp_eq_u32 s8, s9
    s_cselect_b32 s8, s54, s8
    s_add_u32 s52, s50, 16384
    s_add_u32 s53, s8, 0
    s_mov_b32 m0, s52
    s_nop 0
    buffer_load_dwordx4 v3, s[36:39], s53 offen lds
    s_add_u32 s52, s50, 17408
    s_add_u32 s53, s8, 8192
    s_mov_b32 m0, s52
    s_nop 0
    buffer_load_dwordx4 v3, s[36:39], s53 offen lds
    s_add_u32 s52, s50, 18432
    s_add_u32 s53, s8, 16384
    s_mov_b32 m0, s52
    s_nop 0
    buffer_load_dwordx4 v3, s[36:39], s53 offen lds
    s_add_u32 s52, s50, 19456
    s_add_u32 s53, s8, 24576
    s_mov_b32 m0, s52
    s_nop 0
    buffer_load_dwordx4 v3, s[36:39], s53 offen lds
    s_add_u32 s8, s8, 32768
    s_cmp_eq_u32 s8, s9
    s_cselect_b32 s8, s54, s8
    s_branch G_common
G_pre:
    s_mov_b32 s36, s22
    s_mov_b32 s37, s23
    s_mov_b32 s38, 0x1c0000
    s_mov_b32 s39, 0x00020000
    s_mov_b32 s40, s16
    s_mov_b32 s41, s17
    s_mov_b32 s42, 0x80000
    s_mov_b32 s43, 0x00020000
    v_lshrrev_b32 v14, 3, v1
    v_mul_u32_u24 v14, 1024, v14
    v_and_b32 v15, 7, v1
    v_bfe_u32 v3, v1, 4, 1
    v_lshlrev_b32 v3, 2, v3
    v_xor_b32 v15, v15, v3
    v_lshl_add_u32 v3, v15, 4, v14
    s_mul_i32 s50, s6, 20480
    s_add_u32 s50, s50, 0
    s_lshl_b32 s52, s5, 7
    s_mul_i32 s54, s6, 458752
    s_add_u32 s54, s54, s52
    s_lshl_b32 s57, s6, 17
    s_add_u32 s57, s57, s52
    v_lshrrev_b32 v14, 5, v1
    v_bfe_u32 v15, v1, 2, 2
    v_lshl_add_u32 v14, v14, 2, v15
    v_lshlrev_b32 v14, 7, v14
    v_lshrrev_b32 v15, 1, v15
    v_lshl_add_u32 v14, v15, 6, v14
    v_bfe_u32 v15, v1, 4, 1
    v_lshl_add_u32 v14, v15, 5, v14
    v_and_b32 v15, 3, v1
    v_lshl_add_u32 v14, v15, 3, v14
    v_add_u32 v12, s50, v14
    v_xor_b32 v13, 64, v12
    s_and_b32 s8, s4, 7
    s_mul_i32 s8, s8, 2
    s_and_b32 s9, s5, 3
    s_mul_i32 s9, s9, 4
    s_add_u32 s8, s8, s9
    s_sub_u32 s9, s8, 14
    s_cmp_ge_u32 s8, 14
    s_cselect_b32 s8, s9, s8
    s_sub_u32 s9, s8, 14
    s_cmp_ge_u32 s8, 14
    s_cselect_b32 s8, s9, s8
    s_lshl_b32 s10, s8, 11
    s_lshl_b32 s8, s8, 15
    s_add_u32 s8, s8, s54
    s_add_u32 s9, s54, 458752
    v_mov_b32 v14, 162088
lw_13:
    ds_read_b32 v15, v14
    s_waitcnt lgkmcnt(0)
    v_readfirstlane_b32 s52, v15
    s_cmp_ge_u32 s52, 4
    s_cbranch_scc1 lw_13_d
    s_sleep 1
    s_add_u32 s58, s58, 1
    s_cmp_lt_u32 s58, 200000
    s_cbranch_scc1 lw_13
lw_13_d:
    v_mov_b32 v14, 162064
lw_14:
    ds_read_b32 v15, v14
    s_waitcnt lgkmcnt(0)
    v_readfirstlane_b32 s52, v15
    s_cmp_ge_u32 s52, 4
    s_cbranch_scc1 lw_14_d
    s_sleep 1
    s_add_u32 s58, s58, 1
    s_cmp_lt_u32 s58, 200000
    s_cbranch_scc1 lw_14
lw_14_d:
    v_mov_b32 v14, 162052
lw_15:
    ds_read_b32 v15, v14
    s_waitcnt lgkmcnt(0)
    v_readfirstlane_b32 s52, v15
    s_cmp_ge_u32 s52, 4
    s_cbranch_scc1 lw_15_d
    s_sleep 1
    s_add_u32 s58, s58, 1
    s_cmp_lt_u32 s58, 200000
    s_cbranch_scc1 lw_15
lw_15_d:
    v_mov_b32 v14, 162084
lw_16:
    ds_read_b32 v15, v14
    s_waitcnt lgkmcnt(0)
    v_readfirstlane_b32 s52, v15
    s_cmp_ge_u32 s52, 2
    s_cbranch_scc1 lw_16_d
    s_sleep 1
    s_add_u32 s58, s58, 1
    s_cmp_lt_u32 s58, 200000
    s_cbranch_scc1 lw_16
lw_16_d:
    s_add_u32 s52, s50, 0
    s_add_u32 s53, s8, 0
    s_mov_b32 m0, s52
    s_nop 0
    buffer_load_dwordx4 v3, s[36:39], s53 offen lds
    s_add_u32 s52, s50, 1024
    s_add_u32 s53, s8, 8192
    s_mov_b32 m0, s52
    s_nop 0
    buffer_load_dwordx4 v3, s[36:39], s53 offen lds
    s_add_u32 s52, s50, 2048
    s_add_u32 s53, s8, 16384
    s_mov_b32 m0, s52
    s_nop 0
    buffer_load_dwordx4 v3, s[36:39], s53 offen lds
    s_add_u32 s52, s50, 3072
    s_add_u32 s53, s8, 24576
    s_mov_b32 m0, s52
    s_nop 0
    buffer_load_dwordx4 v3, s[36:39], s53 offen lds
    s_add_u32 s8, s8, 32768
    s_cmp_eq_u32 s8, s9
    s_cselect_b32 s8, s54, s8
    s_add_u32 s52, s50, 4096
    s_add_u32 s53, s8, 0
    s_mov_b32 m0, s52
    s_nop 0
    buffer_load_dwordx4 v3, s[36:39], s53 offen lds
    s_add_u32 s52, s50, 5120
    s_add_u32 s53, s8, 8192
    s_mov_b32 m0, s52
    s_nop 0
    buffer_load_dwordx4 v3, s[36:39], s53 offen lds
    s_add_u32 s52, s50, 6144
    s_add_u32 s53, s8, 16384
    s_mov_b32 m0, s52
    s_nop 0
    buffer_load_dwordx4 v3, s[36:39], s53 offen lds
    s_add_u32 s52, s50, 7168
    s_add_u32 s53, s8, 24576
    s_mov_b32 m0, s52
    s_nop 0
    buffer_load_dwordx4 v3, s[36:39], s53 offen lds
    s_add_u32 s8, s8, 32768
    s_cmp_eq_u32 s8, s9
    s_cselect_b32 s8, s54, s8
    s_add_u32 s52, s50, 8192
    s_add_u32 s53, s8, 0
    s_mov_b32 m0, s52
    s_nop 0
    buffer_load_dwordx4 v3, s[36:39], s53 offen lds
    s_add_u32 s52, s50, 9216
    s_add_u32 s53, s8, 8192
    s_mov_b32 m0, s52
    s_nop 0
    buffer_load_dwordx4 v3, s[36:39], s53 offen lds
    s_add_u32 s52, s50, 10240
    s_add_u32 s53, s8, 16384
    s_mov_b32 m0, s52
    s_nop 0
    buffer_load_dwordx4 v3, s[36:39], s53 offen lds
    s_add_u32 s52, s50, 11264
    s_add_u32 s53, s8, 24576
    s_mov_b32 m0, s52
    s_nop 0
    buffer_load_dwordx4 v3, s[36:39], s53 offen lds
    s_add_u32 s8, s8, 32768
    s_cmp_eq_u32 s8, s9
    s_cselect_b32 s8, s54, s8
    s_add_u32 s52, s50, 12288
    s_add_u32 s53, s8, 0
    s_mov_b32 m0, s52
    s_nop 0
    buffer_load_dwordx4 v3, s[36:39], s53 offen lds
    s_add_u32 s52, s50, 13312
    s_add_u32 s53, s8, 8192
    s_mov_b32 m0, s52
    s_nop 0
    buffer_load_dwordx4 v3, s[36:39], s53 offen lds
    s_add_u32 s52, s50, 14336
    s_add_u32 s53, s8, 16384
    s_mov_b32 m0, s52
    s_nop 0
    buffer_load_dwordx4 v3, s[36:39], s53 offen lds
    s_add_u32 s52, s50, 15360
    s_add_u32 s53, s8, 24576
    s_mov_b32 m0, s52
    s_nop 0
    buffer_load_dwordx4 v3, s[36:39], s53 offen lds
    s_add_u32 s8, s8, 32768
    s_cmp_eq_u32 s8, s9
    s_cselect_b32 s8, s54, s8
    s_add_u32 s52, s50, 16384
    s_add_u32 s53, s8, 0
    s_mov_b32 m0, s52
    s_nop 0
    buffer_load_dwordx4 v3, s[36:39], s53 offen lds
    s_add_u32 s52, s50, 17408
    s_add_u32 s53, s8, 8192
    s_mov_b32 m0, s52
    s_nop 0
    buffer_load_dwordx4 v3, s[36:39], s53 offen lds
    s_add_u32 s52, s50, 18432
    s_add_u32 s53, s8, 16384
    s_mov_b32 m0, s52
    s_nop 0
    buffer_load_dwordx4 v3, s[36:39], s53 offen lds
    s_add_u32 s52, s50, 19456
    s_add_u32 s53, s8, 24576
    s_mov_b32 m0, s52
    s_nop 0
    buffer_load_dwordx4 v3, s[36:39], s53 offen lds
    s_add_u32 s8, s8, 32768
    s_cmp_eq_u32 s8, s9
    s_cselect_b32 s8, s54, s8
G_common:
    s_mov_b32 s32, s26
    s_mov_b32 s33, s27
    s_mov_b32 s34, 0x200000
    s_mov_b32 s35, 0x00020000
    s_mul_i32 s55, s4, 229376
    s_mul_i32 s52, s6, 28672
    s_add_u32 s55, s55, s52
    s_add_u32 s55, s55, 4194304
    s_add_u32 s56, s55, 114688
    s_lshl_b32 s61, s4, 11
    s_add_u32 s61, s61, 2293760
    v_and_b32 v4, 15, v1
    v_lshlrev_b32 v4, 7, v4
    s_waitcnt vmcnt(0)
    ds_read_b64_tr_b16 v[80:81], v12 offset:0
    ds_read_b64_tr_b16 v[82:83], v12 offset:1024
    ds_read_b64_tr_b16 v[84:85], v13 offset:0
    ds_read_b64_tr_b16 v[86:87], v13 offset:1024
    ds_read_b64_tr_b16 v[88:89], v12 offset:2048
    ds_read_b64_tr_b16 v[90:91], v12 offset:3072
    ds_read_b64_tr_b16 v[92:93], v13 offset:2048
    ds_read_b64_tr_b16 v[94:95], v13 offset:3072
    ds_read_b64_tr_b16 v[96:97], v12 offset:4096
    ds_read_b64_tr_b16 v[98:99], v12 offset:5120
    ds_read_b64_tr_b16 v[100:101], v13 offset:4096
    ds_read_b64_tr_b16 v[102:103], v13 offset:5120
    ds_read_b64_tr_b16 v[104:105], v12 offset:6144
    ds_read_b64_tr_b16 v[106:107], v12 offset:7168
    ds_read_b64_tr_b16 v[108:109], v13 offset:6144
    ds_read_b64_tr_b16 v[110:111], v13 offset:7168
    ds_read_b64_tr_b16 v[112:113], v12 offset:8192
    ds_read_b64_tr_b16 v[114:115], v12 offset:9216
    ds_read_b64_tr_b16 v[116:117], v13 offset:8192
    ds_read_b64_tr_b16 v[118:119], v13 offset:9216
    ds_read_b64_tr_b16 v[120:121], v12 offset:10240
    ds_read_b64_tr_b16 v[122:123], v12 offset:11264
    ds_read_b64_tr_b16 v[124:125], v13 offset:10240
    ds_read_b64_tr_b16 v[126:127], v13 offset:11264
    ds_read_b64_tr_b16 v[128:129], v12 offset:12288
    ds_read_b64_tr_b16 v[130:131], v12 offset:13312
    ds_read_b64_tr_b16 v[132:133], v13 offset:12288
    ds_read_b64_tr_b16 v[134:135], v13 offset:13312
    ds_read_b64_tr_b16 v[136:137], v12 offset:14336
    ds_read_b64_tr_b16 v[138:139], v12 offset:15360
    ds_read_b64_tr_b16 v[140:141], v13 offset:14336
    ds_read_b64_tr_b16 v[142:143], v13 offset:15360
    ds_read_b64_tr_b16 v[144:145], v12 offset:16384
    ds_read_b64_tr_b16 v[146:147], v12 offset:17408
    ds_read_b64_tr_b16 v[148:149], v13 offset:16384
    ds_read_b64_tr_b16 v[150:151], v13 offset:17408
    ds_read_b64_tr_b16 v[152:153], v12 offset:18432
    ds_read_b64_tr_b16 v[154:155], v12 offset:19456
    ds_read_b64_tr_b16 v[156:157], v13 offset:18432
    ds_read_b64_tr_b16 v[158:159], v13 offset:19456
    s_mov_b32 s52, 0x03
    s_cmp_eq_u32 s6, 1
    s_cselect_b32 s52, 0x0e, s52
    s_cmp_eq_u32 s6, 2
    s_cselect_b32 s52, 0x38, s52
    s_cmp_eq_u32 s6, 3
    s_cselect_b32 s51, 0x60, s52
    v_mov_b32 v14, 162112
lw_17:
    ds_read_b32 v15, v14
    s_waitcnt lgkmcnt(0)
    v_readfirstlane_b32 s52, v15
    s_cmp_ge_u32 s52, 1
    s_cbranch_scc1 lw_17_d
    s_sleep 1
    s_add_u32 s58, s58, 1
    s_cmp_lt_u32 s58, 200000
    s_cbranch_scc1 lw_17
lw_17_d:
    s_mov_b32 exec_lo, s51
    s_mov_b32 exec_hi, 0
G_hp:
    buffer_load_dword v14, v4, s[44:47], s61 offen sc1
    s_waitcnt vmcnt(0)
    v_cmp_ne_u32 vcc, 0, v14
    s_cmp_eq_u32 vcc_lo, s51
    s_cbranch_scc1 G_hp_d
    s_sleep 2
    s_add_u32 s58, s58, 1
    s_cmp_lt_u32 s58, 200000
    s_cbranch_scc1 G_hp
G_hp_d:
    s_mov_b64 exec, -1
    s_add_u32 s53, s55, s10
    buffer_load_dwordx4 v[160:163], v2, s[44:47], s53 offen offset:0 sc1
    buffer_load_dwordx4 v[168:171], v2, s[44:47], s53 offen offset:1024 sc1
    s_add_u32 s53, s56, s10
    buffer_load_dwordx4 v[164:167], v2, s[44:47], s53 offen offset:0 sc1
    buffer_load_dwordx4 v[172:175], v2, s[44:47], s53 offen offset:1024 sc1
    s_add_u32 s10, s10, 2048
    s_cmp_eq_u32 s10, 28672
    s_cselect_b32 s10, 0, s10
    s_add_u32 s53, s55, s10
    buffer_load_dwordx4 v[176:179], v2, s[44:47], s53 offen offset:0 sc1
    buffer_load_dwordx4 v[184:187], v2, s[44:47], s53 offen offset:1024 sc1
    s_add_u32 s53, s56, s10
    buffer_load_dwordx4 v[180:183], v2, s[44:47], s53 offen offset:0 sc1
    buffer_load_dwordx4 v[188:191], v2, s[44:47], s53 offen offset:1024 sc1
    s_add_u32 s10, s10, 2048
    s_cmp_eq_u32 s10, 28672
    s_cselect_b32 s10, 0, s10
    s_add_u32 s53, s55, s10
    buffer_load_dwordx4 v[192:195], v2, s[44:47], s53 offen offset:0 sc1
    buffer_load_dwordx4 v[200:203], v2, s[44:47], s53 offen offset:1024 sc1
    s_add_u32 s53, s56, s10
    buffer_load_dwordx4 v[196:199], v2, s[44:47], s53 offen offset:0 sc1
    buffer_load_dwordx4 v[204:207], v2, s[44:47], s53 offen offset:1024 sc1
    s_add_u32 s10, s10, 2048
    s_cmp_eq_u32 s10, 28672
    s_cselect_b32 s10, 0, s10
    s_add_u32 s53, s55, s10
    buffer_load_dwordx4 v[208:211], v2, s[44:47], s53 offen offset:0 sc1
    buffer_load_dwordx4 v[216:219], v2, s[44:47], s53 offen offset:1024 sc1
    s_add_u32 s53, s56, s10
    buffer_load_dwordx4 v[212:215], v2, s[44:47], s53 offen offset:0 sc1
    buffer_load_dwordx4 v[220:223], v2, s[44:47], s53 offen offset:1024 sc1
    s_add_u32 s10, s10, 2048
    s_cmp_eq_u32 s10, 28672
    s_cselect_b32 s10, 0, s10
    s_add_u32 s53, s55, s10
    buffer_load_dwordx4 v[224:227], v2, s[44:47], s53 offen offset:0 sc1
    buffer_load_dwordx4 v[232:235], v2, s[44:47], s53 offen offset:1024 sc1
    s_add_u32 s53, s56, s10
    buffer_load_dwordx4 v[228:231], v2, s[44:47], s53 offen offset:0 sc1
    buffer_load_dwordx4 v[236:239], v2, s[44:47], s53 offen offset:1024 sc1
    s_add_u32 s10, s10, 2048
    s_cmp_eq_u32 s10, 28672
    s_cselect_b32 s10, 0, s10
    s_add_u32 s53, s55, s10
    buffer_load_dwordx4 v[240:243], v2, s[44:47], s53 offen offset:0 sc1
    buffer_load_dwordx4 v[248:251], v2, s[44:47], s53 offen offset:1024 sc1
    s_add_u32 s53, s56, s10
    buffer_load_dwordx4 v[244:247], v2, s[44:47], s53 offen offset:0 sc1
    buffer_load_dwordx4 v[252:255], v2, s[44:47], s53 offen offset:1024 sc1
    s_add_u32 s10, s10, 2048
    s_cmp_eq_u32 s10, 28672
    s_cselect_b32 s10, 0, s10
    s_waitcnt lgkmcnt(0)
    s_add_u32 s52, s50, 0
    s_add_u32 s53, s8, 0
    s_mov_b32 m0, s52
    s_nop 0
    buffer_load_dwordx4 v3, s[36:39], s53 offen lds
    s_add_u32 s52, s50, 1024
    s_add_u32 s53, s8, 8192
    s_mov_b32 m0, s52
    s_nop 0
    buffer_load_dwordx4 v3, s[36:39], s53 offen lds
    s_add_u32 s52, s50, 2048
    s_add_u32 s53, s8, 16384
    s_mov_b32 m0, s52
    s_nop 0
    buffer_load_dwordx4 v3, s[36:39], s53 offen lds
    s_add_u32 s52, s50, 3072
    s_add_u32 s53, s8, 24576
    s_mov_b32 m0, s52
    s_nop 0
    buffer_load_dwordx4 v3, s[36:39], s53 offen lds
    s_add_u32 s8, s8, 32768
    s_cmp_eq_u32 s8, s9
    s_cselect_b32 s8, s54, s8
    s_add_u32 s52, s50, 4096
    s_add_u32 s53, s8, 0
    s_mov_b32 m0, s52
    s_nop 0
    buffer_load_dwordx4 v3, s[36:39], s53 offen lds
    s_add_u32 s52, s50, 5120
    s_add_u32 s53, s8, 8192
    s_mov_b32 m0, s52
    s_nop 0
    buffer_load_dwordx4 v3, s[36:39], s53 offen lds
    s_add_u32 s52, s50, 6144
    s_add_u32 s53, s8, 16384
    s_mov_b32 m0, s52
    s_nop 0
    buffer_load_dwordx4 v3, s[36:39], s53 offen lds
    s_add_u32 s52, s50, 7168
    s_add_u32 s53, s8, 24576
    s_mov_b32 m0, s52
    s_nop 0
    buffer_load_dwordx4 v3, s[36:39], s53 offen lds
    s_add_u32 s8, s8, 32768
    s_cmp_eq_u32 s8, s9
    s_cselect_b32 s8, s54, s8
    s_add_u32 s52, s50, 8192
    s_add_u32 s53, s8, 0
    s_mov_b32 m0, s52
    s_nop 0
    buffer_load_dwordx4 v3, s[36:39], s53 offen lds
    s_add_u32 s52, s50, 9216
    s_add_u32 s53, s8, 8192
    s_mov_b32 m0, s52
    s_nop 0
    buffer_load_dwordx4 v3, s[36:39], s53 offen lds
    s_add_u32 s52, s50, 10240
    s_add_u32 s53, s8, 16384
    s_mov_b32 m0, s52
    s_nop 0
    buffer_load_dwordx4 v3, s[36:39], s53 offen lds
    s_add_u32 s52, s50, 11264
    s_add_u32 s53, s8, 24576
    s_mov_b32 m0, s52
    s_nop 0
    buffer_load_dwordx4 v3, s[36:39], s53 offen lds
    s_add_u32 s8, s8, 32768
    s_cmp_eq_u32 s8, s9
    s_cselect_b32 s8, s54, s8
    s_add_u32 s52, s50, 12288
    s_add_u32 s53, s8, 0
    s_mov_b32 m0, s52
    s_nop 0
    buffer_load_dwordx4 v3, s[36:39], s53 offen lds
    s_add_u32 s52, s50, 13312
    s_add_u32 s53, s8, 8192
    s_mov_b32 m0, s52
    s_nop 0
    buffer_load_dwordx4 v3, s[36:39], s53 offen lds
    s_add_u32 s52, s50, 14336
    s_add_u32 s53, s8, 16384
    s_mov_b32 m0, s52
    s_nop 0
    buffer_load_dwordx4 v3, s[36:39], s53 offen lds
    s_add_u32 s52, s50, 15360
    s_add_u32 s53, s8, 24576
    s_mov_b32 m0, s52
    s_nop 0
    buffer_load_dwordx4 v3, s[36:39], s53 offen lds
    s_add_u32 s8, s8, 32768
    s_cmp_eq_u32 s8, s9
    s_cselect_b32 s8, s54, s8
    s_add_u32 s52, s50, 16384
    s_add_u32 s53, s8, 0
    s_mov_b32 m0, s52
    s_nop 0
    buffer_load_dwordx4 v3, s[36:39], s53 offen lds
    s_add_u32 s52, s50, 17408
    s_add_u32 s53, s8, 8192
    s_mov_b32 m0, s52
    s_nop 0
    buffer_load_dwordx4 v3, s[36:39], s53 offen lds
    s_add_u32 s52, s50, 18432
    s_add_u32 s53, s8, 16384
    s_mov_b32 m0, s52
    s_nop 0
    buffer_load_dwordx4 v3, s[36:39], s53 offen lds
    s_add_u32 s52, s50, 19456
    s_add_u32 s53, s8, 24576
    s_mov_b32 m0, s52
    s_nop 0
    buffer_load_dwordx4 v3, s[36:39], s53 offen lds
    s_add_u32 s8, s8, 32768
    s_cmp_eq_u32 s8, s9
    s_cselect_b32 s8, s54, s8
    s_waitcnt vmcnt(40)
    s_waitcnt lgkmcnt(0)
    v_mfma_f32_32x32x16_bf16 v[16:31], v[80:83], v[160:163], 0
    v_mfma_f32_32x32x16_bf16 v[32:47], v[80:83], v[164:167], 0
    v_mfma_f32_32x32x16_bf16 v[48:63], v[84:87], v[160:163], 0
    v_mfma_f32_32x32x16_bf16 v[64:79], v[84:87], v[164:167], 0
    v_mfma_f32_32x32x16_bf16 v[16:31], v[88:91], v[168:171], v[16:31]
    v_mfma_f32_32x32x16_bf16 v[32:47], v[88:91], v[172:175], v[32:47]
    v_mfma_f32_32x32x16_bf16 v[48:63], v[92:95], v[168:171], v[48:63]
    v_mfma_f32_32x32x16_bf16 v[64:79], v[92:95], v[172:175], v[64:79]
    s_nop 3
    s_add_u32 s53, s55, s10
    buffer_load_dwordx4 v[160:163], v2, s[44:47], s53 offen offset:0 sc1
    buffer_load_dwordx4 v[168:171], v2, s[44:47], s53 offen offset:1024 sc1
    s_add_u32 s53, s56, s10
    buffer_load_dwordx4 v[164:167], v2, s[44:47], s53 offen offset:0 sc1
    buffer_load_dwordx4 v[172:175], v2, s[44:47], s53 offen offset:1024 sc1
    s_add_u32 s10, s10, 2048
    s_cmp_eq_u32 s10, 28672
    s_cselect_b32 s10, 0, s10
    s_waitcnt vmcnt(40)
    s_waitcnt lgkmcnt(0)
    v_mfma_f32_32x32x16_bf16 v[16:31], v[96:99], v[176:179], v[16:31]
    v_mfma_f32_32x32x16_bf16 v[32:47], v[96:99], v[180:183], v[32:47]
    v_mfma_f32_32x32x16_bf16 v[48:63], v[100:103], v[176:179], v[48:63]
    v_mfma_f32_32x32x16_bf16 v[64:79], v[100:103], v[180:183], v[64:79]
    v_mfma_f32_32x32x16_bf16 v[16:31], v[104:107], v[184:187], v[16:31]
    v_mfma_f32_32x32x16_bf16 v[32:47], v[104:107], v[188:191], v[32:47]
    v_mfma_f32_32x32x16_bf16 v[48:63], v[108:111], v[184:187], v[48:63]
    v_mfma_f32_32x32x16_bf16 v[64:79], v[108:111], v[188:191], v[64:79]
    s_nop 3
    s_add_u32 s53, s55, s10
    buffer_load_dwordx4 v[176:179], v2, s[44:47], s53 offen offset:0 sc1
    buffer_load_dwordx4 v[184:187], v2, s[44:47], s53 offen offset:1024 sc1
    s_add_u32 s53, s56, s10
    buffer_load_dwordx4 v[180:183], v2, s[44:47], s53 offen offset:0 sc1
    buffer_load_dwordx4 v[188:191], v2, s[44:47], s53 offen offset:1024 sc1
    s_add_u32 s10, s10, 2048
    s_cmp_eq_u32 s10, 28672
    s_cselect_b32 s10, 0, s10
    s_waitcnt vmcnt(40)
    s_waitcnt lgkmcnt(0)
    v_mfma_f32_32x32x16_bf16 v[16:31], v[112:115], v[192:195], v[16:31]
    v_mfma_f32_32x32x16_bf16 v[32:47], v[112:115], v[196:199], v[32:47]
    v_mfma_f32_32x32x16_bf16 v[48:63], v[116:119], v[192:195], v[48:63]
    v_mfma_f32_32x32x16_bf16 v[64:79], v[116:119], v[196:199], v[64:79]
    v_mfma_f32_32x32x16_bf16 v[16:31], v[120:123], v[200:203], v[16:31]
    v_mfma_f32_32x32x16_bf16 v[32:47], v[120:123], v[204:207], v[32:47]
    v_mfma_f32_32x32x16_bf16 v[48:63], v[124:127], v[200:203], v[48:63]
    v_mfma_f32_32x32x16_bf16 v[64:79], v[124:127], v[204:207], v[64:79]
    s_nop 3
    s_add_u32 s53, s55, s10
    buffer_load_dwordx4 v[192:195], v2, s[44:47], s53 offen offset:0 sc1
    buffer_load_dwordx4 v[200:203], v2, s[44:47], s53 offen offset:1024 sc1
    s_add_u32 s53, s56, s10
    buffer_load_dwordx4 v[196:199], v2, s[44:47], s53 offen offset:0 sc1
    buffer_load_dwordx4 v[204:207], v2, s[44:47], s53 offen offset:1024 sc1
    s_add_u32 s10, s10, 2048
    s_cmp_eq_u32 s10, 28672
    s_cselect_b32 s10, 0, s10
    s_waitcnt vmcnt(40)
    s_waitcnt lgkmcnt(0)
    v_mfma_f32_32x32x16_bf16 v[16:31], v[128:131], v[208:211], v[16:31]
    v_mfma_f32_32x32x16_bf16 v[32:47], v[128:131], v[212:215], v[32:47]
    v_mfma_f32_32x32x16_bf16 v[48:63], v[132:135], v[208:211], v[48:63]
    v_mfma_f32_32x32x16_bf16 v[64:79], v[132:135], v[212:215], v[64:79]
    v_mfma_f32_32x32x16_bf16 v[16:31], v[136:139], v[216:219], v[16:31]
    v_mfma_f32_32x32x16_bf16 v[32:47], v[136:139], v[220:223], v[32:47]
    v_mfma_f32_32x32x16_bf16 v[48:63], v[140:143], v[216:219], v[48:63]
    v_mfma_f32_32x32x16_bf16 v[64:79], v[140:143], v[220:223], v[64:79]
    s_nop 3
    s_add_u32 s53, s55, s10
    buffer_load_dwordx4 v[208:211], v2, s[44:47], s53 offen offset:0 sc1
    buffer_load_dwordx4 v[216:219], v2, s[44:47], s53 offen offset:1024 sc1
    s_add_u32 s53, s56, s10
    buffer_load_dwordx4 v[212:215], v2, s[44:47], s53 offen offset:0 sc1
    buffer_load_dwordx4 v[220:223], v2, s[44:47], s53 offen offset:1024 sc1
    s_add_u32 s10, s10, 2048
    s_cmp_eq_u32 s10, 28672
    s_cselect_b32 s10, 0, s10
    s_waitcnt vmcnt(32)
    ds_read_b64_tr_b16 v[80:81], v12 offset:0
    ds_read_b64_tr_b16 v[82:83], v12 offset:1024
    ds_read_b64_tr_b16 v[84:85], v13 offset:0
    ds_read_b64_tr_b16 v[86:87], v13 offset:1024
    ds_read_b64_tr_b16 v[88:89], v12 offset:2048
    ds_read_b64_tr_b16 v[90:91], v12 offset:3072
    ds_read_b64_tr_b16 v[92:93], v13 offset:2048
    ds_read_b64_tr_b16 v[94:95], v13 offset:3072
    s_waitcnt lgkmcnt(0)
    v_mfma_f32_32x32x16_bf16 v[16:31], v[144:147], v[224:227], v[16:31]
    v_mfma_f32_32x32x16_bf16 v[32:47], v[144:147], v[228:231], v[32:47]
    v_mfma_f32_32x32x16_bf16 v[48:63], v[148:151], v[224:227], v[48:63]
    v_mfma_f32_32x32x16_bf16 v[64:79], v[148:151], v[228:231], v[64:79]
    v_mfma_f32_32x32x16_bf16 v[16:31], v[152:155], v[232:235], v[16:31]
    v_mfma_f32_32x32x16_bf16 v[32:47], v[152:155], v[236:239], v[32:47]
    v_mfma_f32_32x32x16_bf16 v[48:63], v[156:159], v[232:235], v[48:63]
    v_mfma_f32_32x32x16_bf16 v[64:79], v[156:159], v[236:239], v[64:79]
    s_add_u32 s52, s50, 0
    s_add_u32 s53, s8, 0
    s_mov_b32 m0, s52
    s_nop 0
    buffer_load_dwordx4 v3, s[36:39], s53 offen lds
    s_add_u32 s52, s50, 1024
    s_add_u32 s53, s8, 8192
    s_mov_b32 m0, s52
    s_nop 0
    buffer_load_dwordx4 v3, s[36:39], s53 offen lds
    s_add_u32 s52, s50, 2048
    s_add_u32 s53, s8, 16384
    s_mov_b32 m0, s52
    s_nop 0
    buffer_load_dwordx4 v3, s[36:39], s53 offen lds
    s_add_u32 s52, s50, 3072
    s_add_u32 s53, s8, 24576
    s_mov_b32 m0, s52
    s_nop 0
    buffer_load_dwordx4 v3, s[36:39], s53 offen lds
    s_add_u32 s8, s8, 32768
    s_cmp_eq_u32 s8, s9
    s_cselect_b32 s8, s54, s8
    s_nop 3
    s_add_u32 s53, s55, s10
    buffer_load_dwordx4 v[224:227], v2, s[44:47], s53 offen offset:0 sc1
    buffer_load_dwordx4 v[232:235], v2, s[44:47], s53 offen offset:1024 sc1
    s_add_u32 s53, s56, s10
    buffer_load_dwordx4 v[228:231], v2, s[44:47], s53 offen offset:0 sc1
    buffer_load_dwordx4 v[236:239], v2, s[44:47], s53 offen offset:1024 sc1
    s_add_u32 s10, s10, 2048
    s_cmp_eq_u32 s10, 28672
    s_cselect_b32 s10, 0, s10
    s_waitcnt vmcnt(36)
    ds_read_b64_tr_b16 v[96:97], v12 offset:4096
    ds_read_b64_tr_b16 v[98:99], v12 offset:5120
    ds_read_b64_tr_b16 v[100:101], v13 offset:4096
    ds_read_b64_tr_b16 v[102:103], v13 offset:5120
    ds_read_b64_tr_b16 v[104:105], v12 offset:6144
    ds_read_b64_tr_b16 v[106:107], v12 offset:7168
    ds_read_b64_tr_b16 v[108:109], v13 offset:6144
    ds_read_b64_tr_b16 v[110:111], v13 offset:7168
    s_waitcnt lgkmcnt(0)
    v_mfma_f32_32x32x16_bf16 v[16:31], v[80:83], v[240:243], v[16:31]
    v_mfma_f32_32x32x16_bf16 v[32:47], v[80:83], v[244:247], v[32:47]
    v_mfma_f32_32x32x16_bf16 v[48:63], v[84:87], v[240:243], v[48:63]
    v_mfma_f32_32x32x16_bf16 v[64:79], v[84:87], v[244:247], v[64:79]
    v_mfma_f32_32x32x16_bf16 v[16:31], v[88:91], v[248:251], v[16:31]
    v_mfma_f32_32x32x16_bf16 v[32:47], v[88:91], v[252:255], v[32:47]
    v_mfma_f32_32x32x16_bf16 v[48:63], v[92:95], v[248:251], v[48:63]
    v_mfma_f32_32x32x16_bf16 v[64:79], v[92:95], v[252:255], v[64:79]
    s_add_u32 s52, s50, 4096
    s_add_u32 s53, s8, 0
    s_mov_b32 m0, s52
    s_nop 0
    buffer_load_dwordx4 v3, s[36:39], s53 offen lds
    s_add_u32 s52, s50, 5120
    s_add_u32 s53, s8, 8192
    s_mov_b32 m0, s52
    s_nop 0
    buffer_load_dwordx4 v3, s[36:39], s53 offen lds
    s_add_u32 s52, s50, 6144
    s_add_u32 s53, s8, 16384
    s_mov_b32 m0, s52
    s_nop 0
    buffer_load_dwordx4 v3, s[36:39], s53 offen lds
    s_add_u32 s52, s50, 7168
    s_add_u32 s53, s8, 24576
    s_mov_b32 m0, s52
    s_nop 0
    buffer_load_dwordx4 v3, s[36:39], s53 offen lds
    s_add_u32 s8, s8, 32768
    s_cmp_eq_u32 s8, s9
    s_cselect_b32 s8, s54, s8
    s_nop 3
    s_add_u32 s53, s55, s10
    buffer_load_dwordx4 v[240:243], v2, s[44:47], s53 offen offset:0 sc1
    buffer_load_dwordx4 v[248:251], v2, s[44:47], s53 offen offset:1024 sc1
    s_add_u32 s53, s56, s10
    buffer_load_dwordx4 v[244:247], v2, s[44:47], s53 offen offset:0 sc1
    buffer_load_dwordx4 v[252:255], v2, s[44:47], s53 offen offset:1024 sc1
    s_add_u32 s10, s10, 2048
    s_cmp_eq_u32 s10, 28672
    s_cselect_b32 s10, 0, s10
    s_waitcnt vmcnt(40)
    ds_read_b64_tr_b16 v[112:113], v12 offset:8192
    ds_read_b64_tr_b16 v[114:115], v12 offset:9216
    ds_read_b64_tr_b16 v[116:117], v13 offset:8192
    ds_read_b64_tr_b16 v[118:119], v13 offset:9216
    ds_read_b64_tr_b16 v[120:121], v12 offset:10240
    ds_read_b64_tr_b16 v[122:123], v12 offset:11264
    ds_read_b64_tr_b16 v[124:125], v13 offset:10240
    ds_read_b64_tr_b16 v[126:127], v13 offset:11264
    s_waitcnt vmcnt(28)
    s_waitcnt lgkmcnt(0)
    v_mfma_f32_32x32x16_bf16 v[16:31], v[96:99], v[160:163], v[16:31]
    v_mfma_f32_32x32x16_bf16 v[32:47], v[96:99], v[164:167], v[32:47]
    v_mfma_f32_32x32x16_bf16 v[48:63], v[100:103], v[160:163], v[48:63]
    v_mfma_f32_32x32x16_bf16 v[64:79], v[100:103], v[164:167], v[64:79]
    v_mfma_f32_32x32x16_bf16 v[16:31], v[104:107], v[168:171], v[16:31]
    v_mfma_f32_32x32x16_bf16 v[32:47], v[104:107], v[172:175], v[32:47]
    v_mfma_f32_32x32x16_bf16 v[48:63], v[108:111], v[168:171], v[48:63]
    v_mfma_f32_32x32x16_bf16 v[64:79], v[108:111], v[172:175], v[64:79]
    s_add_u32 s52, s50, 8192
    s_add_u32 s53, s8, 0
    s_mov_b32 m0, s52
    s_nop 0
    buffer_load_dwordx4 v3, s[36:39], s53 offen lds
    s_add_u32 s52, s50, 9216
    s_add_u32 s53, s8, 8192
    s_mov_b32 m0, s52
    s_nop 0
    buffer_load_dwordx4 v3, s[36:39], s53 offen lds
    s_add_u32 s52, s50, 10240
    s_add_u32 s53, s8, 16384
    s_mov_b32 m0, s52
    s_nop 0
    buffer_load_dwordx4 v3, s[36:39], s53 offen lds
    s_add_u32 s52, s50, 11264
    s_add_u32 s53, s8, 24576
    s_mov_b32 m0, s52
    s_nop 0
    buffer_load_dwordx4 v3, s[36:39], s53 offen lds
    s_add_u32 s8, s8, 32768
    s_cmp_eq_u32 s8, s9
    s_cselect_b32 s8, s54, s8
    s_nop 3
    s_add_u32 s53, s55, s10
    buffer_load_dwordx4 v[160:163], v2, s[44:47], s53 offen offset:0 sc1
    buffer_load_dwordx4 v[168:171], v2, s[44:47], s53 offen offset:1024 sc1
    s_add_u32 s53, s56, s10
    buffer_load_dwordx4 v[164:167], v2, s[44:47], s53 offen offset:0 sc1
    buffer_load_dwordx4 v[172:175], v2, s[44:47], s53 offen offset:1024 sc1
    s_add_u32 s10, s10, 2048
    s_cmp_eq_u32 s10, 28672
    s_cselect_b32 s10, 0, s10
    ds_read_b64_tr_b16 v[128:129], v12 offset:12288
    ds_read_b64_tr_b16 v[130:131], v12 offset:13312
    ds_read_b64_tr_b16 v[132:133], v13 offset:12288
    ds_read_b64_tr_b16 v[134:135], v13 offset:13312
    ds_read_b64_tr_b16 v[136:137], v12 offset:14336
    ds_read_b64_tr_b16 v[138:139], v12 offset:15360
    ds_read_b64_tr_b16 v[140:141], v13 offset:14336
    ds_read_b64_tr_b16 v[142:143], v13 offset:15360
    s_waitcnt vmcnt(32)
    s_waitcnt lgkmcnt(0)
    v_mfma_f32_32x32x16_bf16 v[16:31], v[112:115], v[176:179], v[16:31]
    v_mfma_f32_32x32x16_bf16 v[32:47], v[112:115], v[180:183], v[32:47]
    v_mfma_f32_32x32x16_bf16 v[48:63], v[116:119], v[176:179], v[48:63]
    v_mfma_f32_32x32x16_bf16 v[64:79], v[116:119], v[180:183], v[64:79]
    v_mfma_f32_32x32x16_bf16 v[16:31], v[120:123], v[184:187], v[16:31]
    v_mfma_f32_32x32x16_bf16 v[32:47], v[120:123], v[188:191], v[32:47]
    v_mfma_f32_32x32x16_bf16 v[48:63], v[124:127], v[184:187], v[48:63]
    v_mfma_f32_32x32x16_bf16 v[64:79], v[124:127], v[188:191], v[64:79]
    s_add_u32 s52, s50, 12288
    s_add_u32 s53, s8, 0
    s_mov_b32 m0, s52
    s_nop 0
    buffer_load_dwordx4 v3, s[36:39], s53 offen lds
    s_add_u32 s52, s50, 13312
    s_add_u32 s53, s8, 8192
    s_mov_b32 m0, s52
    s_nop 0
    buffer_load_dwordx4 v3, s[36:39], s53 offen lds
    s_add_u32 s52, s50, 14336
    s_add_u32 s53, s8, 16384
    s_mov_b32 m0, s52
    s_nop 0
    buffer_load_dwordx4 v3, s[36:39], s53 offen lds
    s_add_u32 s52, s50, 15360
    s_add_u32 s53, s8, 24576
    s_mov_b32 m0, s52
    s_nop 0
    buffer_load_dwordx4 v3, s[36:39], s53 offen lds
    s_add_u32 s8, s8, 32768
    s_cmp_eq_u32 s8, s9
    s_cselect_b32 s8, s54, s8
    s_nop 3
    s_add_u32 s53, s55, s10
    buffer_load_dwordx4 v[176:179], v2, s[44:47], s53 offen offset:0 sc1
    buffer_load_dwordx4 v[184:187], v2, s[44:47], s53 offen offset:1024 sc1
    s_add_u32 s53, s56, s10
    buffer_load_dwordx4 v[180:183], v2, s[44:47], s53 offen offset:0 sc1
    buffer_load_dwordx4 v[188:191], v2, s[44:47], s53 offen offset:1024 sc1
    s_add_u32 s10, s10, 2048
    s_cmp_eq_u32 s10, 28672
    s_cselect_b32 s10, 0, s10
    ds_read_b64_tr_b16 v[144:145], v12 offset:16384
    ds_read_b64_tr_b16 v[146:147], v12 offset:17408
    ds_read_b64_tr_b16 v[148:149], v13 offset:16384
    ds_read_b64_tr_b16 v[150:151], v13 offset:17408
    ds_read_b64_tr_b16 v[152:153], v12 offset:18432
    ds_read_b64_tr_b16 v[154:155], v12 offset:19456
    ds_read_b64_tr_b16 v[156:157], v13 offset:18432
    ds_read_b64_tr_b16 v[158:159], v13 offset:19456
    s_waitcnt vmcnt(36)
    s_waitcnt lgkmcnt(0)
    v_mfma_f32_32x32x16_bf16 v[16:31], v[128:131], v[192:195], v[16:31]
    v_mfma_f32_32x32x16_bf16 v[32:47], v[128:131], v[196:199], v[32:47]
    v_mfma_f32_32x32x16_bf16 v[48:63], v[132:135], v[192:195], v[48:63]
    v_mfma_f32_32x32x16_bf16 v[64:79], v[132:135], v[196:199], v[64:79]
    v_mfma_f32_32x32x16_bf16 v[16:31], v[136:139], v[200:203], v[16:31]
    v_mfma_f32_32x32x16_bf16 v[32:47], v[136:139], v[204:207], v[32:47]
    v_mfma_f32_32x32x16_bf16 v[48:63], v[140:143], v[200:203], v[48:63]
    v_mfma_f32_32x32x16_bf16 v[64:79], v[140:143], v[204:207], v[64:79]
    s_add_u32 s52, s50, 16384
    s_add_u32 s53, s57, 0
    s_mov_b32 m0, s52
    s_nop 0
    buffer_load_dwordx4 v3, s[40:43], s53 offen lds
    s_add_u32 s52, s50, 17408
    s_add_u32 s53, s57, 8192
    s_mov_b32 m0, s52
    s_nop 0
    buffer_load_dwordx4 v3, s[40:43], s53 offen lds
    s_add_u32 s52, s50, 18432
    s_add_u32 s53, s57, 16384
    s_mov_b32 m0, s52
    s_nop 0
    buffer_load_dwordx4 v3, s[40:43], s53 offen lds
    s_add_u32 s52, s50, 19456
    s_add_u32 s53, s57, 24576
    s_mov_b32 m0, s52
    s_nop 0
    buffer_load_dwordx4 v3, s[40:43], s53 offen lds
    s_nop 3
    s_waitcnt vmcnt(32)
    ds_read_b64_tr_b16 v[80:81], v12 offset:0
    ds_read_b64_tr_b16 v[82:83], v12 offset:1024
    ds_read_b64_tr_b16 v[84:85], v13 offset:0
    ds_read_b64_tr_b16 v[86:87], v13 offset:1024
    ds_read_b64_tr_b16 v[88:89], v12 offset:2048
    ds_read_b64_tr_b16 v[90:91], v12 offset:3072
    ds_read_b64_tr_b16 v[92:93], v13 offset:2048
    ds_read_b64_tr_b16 v[94:95], v13 offset:3072
    s_waitcnt lgkmcnt(0)
    v_mfma_f32_32x32x16_bf16 v[16:31], v[144:147], v[208:211], v[16:31]
    v_mfma_f32_32x32x16_bf16 v[32:47], v[144:147], v[212:215], v[32:47]
    v_mfma_f32_32x32x16_bf16 v[48:63], v[148:151], v[208:211], v[48:63]
    v_mfma_f32_32x32x16_bf16 v[64:79], v[148:151], v[212:215], v[64:79]
    v_mfma_f32_32x32x16_bf16 v[16:31], v[152:155], v[216:219], v[16:31]
    v_mfma_f32_32x32x16_bf16 v[32:47], v[152:155], v[220:223], v[32:47]
    v_mfma_f32_32x32x16_bf16 v[48:63], v[156:159], v[216:219], v[48:63]
    v_mfma_f32_32x32x16_bf16 v[64:79], v[156:159], v[220:223], v[64:79]
    s_add_u32 s52, s50, 0
    s_add_u32 s53, s57, 32768
    s_mov_b32 m0, s52
    s_nop 0
    buffer_load_dwordx4 v3, s[40:43], s53 offen lds
    s_add_u32 s52, s50, 1024
    s_add_u32 s53, s57, 40960
    s_mov_b32 m0, s52
    s_nop 0
    buffer_load_dwordx4 v3, s[40:43], s53 offen lds
    s_add_u32 s52, s50, 2048
    s_add_u32 s53, s57, 49152
    s_mov_b32 m0, s52
    s_nop 0
    buffer_load_dwordx4 v3, s[40:43], s53 offen lds
    s_add_u32 s52, s50, 3072
    s_add_u32 s53, s57, 57344
    s_mov_b32 m0, s52
    s_nop 0
    buffer_load_dwordx4 v3, s[40:43], s53 offen lds
    s_nop 3
    s_waitcnt vmcnt(28)
    ds_read_b64_tr_b16 v[96:97], v12 offset:4096
    ds_read_b64_tr_b16 v[98:99], v12 offset:5120
    ds_read_b64_tr_b16 v[100:101], v13 offset:4096
    ds_read_b64_tr_b16 v[102:103], v13 offset:5120
    ds_read_b64_tr_b16 v[104:105], v12 offset:6144
    ds_read_b64_tr_b16 v[106:107], v12 offset:7168
    ds_read_b64_tr_b16 v[108:109], v13 offset:6144
    ds_read_b64_tr_b16 v[110:111], v13 offset:7168
    s_waitcnt lgkmcnt(0)
    v_mfma_f32_32x32x16_bf16 v[16:31], v[80:83], v[224:227], v[16:31]
    v_mfma_f32_32x32x16_bf16 v[32:47], v[80:83], v[228:231], v[32:47]
    v_mfma_f32_32x32x16_bf16 v[48:63], v[84:87], v[224:227], v[48:63]
    v_mfma_f32_32x32x16_bf16 v[64:79], v[84:87], v[228:231], v[64:79]
    v_mfma_f32_32x32x16_bf16 v[16:31], v[88:91], v[232:235], v[16:31]
    v_mfma_f32_32x32x16_bf16 v[32:47], v[88:91], v[236:239], v[32:47]
    v_mfma_f32_32x32x16_bf16 v[48:63], v[92:95], v[232:235], v[48:63]
    v_mfma_f32_32x32x16_bf16 v[64:79], v[92:95], v[236:239], v[64:79]
    s_add_u32 s52, s50, 4096
    s_add_u32 s53, s57, 65536
    s_mov_b32 m0, s52
    s_nop 0
    buffer_load_dwordx4 v3, s[40:43], s53 offen lds
    s_add_u32 s52, s50, 5120
    s_add_u32 s53, s57, 73728
    s_mov_b32 m0, s52
    s_nop 0
    buffer_load_dwordx4 v3, s[40:43], s53 offen lds
    s_add_u32 s52, s50, 6144
    s_add_u32 s53, s57, 81920
    s_mov_b32 m0, s52
    s_nop 0
    buffer_load_dwordx4 v3, s[40:43], s53 offen lds
    s_add_u32 s52, s50, 7168
    s_add_u32 s53, s57, 90112
    s_mov_b32 m0, s52
    s_nop 0
    buffer_load_dwordx4 v3, s[40:43], s53 offen lds
    s_nop 3
    s_waitcnt vmcnt(24)
    ds_read_b64_tr_b16 v[112:113], v12 offset:8192
    ds_read_b64_tr_b16 v[114:115], v12 offset:9216
    ds_read_b64_tr_b16 v[116:117], v13 offset:8192
    ds_read_b64_tr_b16 v[118:119], v13 offset:9216
    ds_read_b64_tr_b16 v[120:121], v12 offset:10240
    ds_read_b64_tr_b16 v[122:123], v12 offset:11264
    ds_read_b64_tr_b16 v[124:125], v13 offset:10240
    ds_read_b64_tr_b16 v[126:127], v13 offset:11264
    s_waitcnt lgkmcnt(0)
    v_mfma_f32_32x32x16_bf16 v[16:31], v[96:99], v[240:243], v[16:31]
    v_mfma_f32_32x32x16_bf16 v[32:47], v[96:99], v[244:247], v[32:47]
    v_mfma_f32_32x32x16_bf16 v[48:63], v[100:103], v[240:243], v[48:63]
    v_mfma_f32_32x32x16_bf16 v[64:79], v[100:103], v[244:247], v[64:79]
    v_mfma_f32_32x32x16_bf16 v[16:31], v[104:107], v[248:251], v[16:31]
    v_mfma_f32_32x32x16_bf16 v[32:47], v[104:107], v[252:255], v[32:47]
    v_mfma_f32_32x32x16_bf16 v[48:63], v[108:111], v[248:251], v[48:63]
    v_mfma_f32_32x32x16_bf16 v[64:79], v[108:111], v[252:255], v[64:79]
    s_add_u32 s52, s50, 8192
    s_add_u32 s53, s57, 98304
    s_mov_b32 m0, s52
    s_nop 0
    buffer_load_dwordx4 v3, s[40:43], s53 offen lds
    s_add_u32 s52, s50, 9216
    s_add_u32 s53, s57, 106496
    s_mov_b32 m0, s52
    s_nop 0
    buffer_load_dwordx4 v3, s[40:43], s53 offen lds
    s_add_u32 s52, s50, 10240
    s_add_u32 s53, s57, 114688
    s_mov_b32 m0, s52
    s_nop 0
    buffer_load_dwordx4 v3, s[40:43], s53 offen lds
    s_add_u32 s52, s50, 11264
    s_add_u32 s53, s57, 122880
    s_mov_b32 m0, s52
    s_nop 0
    buffer_load_dwordx4 v3, s[40:43], s53 offen lds
    s_nop 3
    s_waitcnt vmcnt(20)
    ds_read_b64_tr_b16 v[128:129], v12 offset:12288
    ds_read_b64_tr_b16 v[130:131], v12 offset:13312
    ds_read_b64_tr_b16 v[132:133], v13 offset:12288
    ds_read_b64_tr_b16 v[134:135], v13 offset:13312
    ds_read_b64_tr_b16 v[136:137], v12 offset:14336
    ds_read_b64_tr_b16 v[138:139], v12 offset:15360
    ds_read_b64_tr_b16 v[140:141], v13 offset:14336
    ds_read_b64_tr_b16 v[142:143], v13 offset:15360
    s_waitcnt lgkmcnt(0)
    v_mfma_f32_32x32x16_bf16 v[16:31], v[112:115], v[160:163], v[16:31]
    v_mfma_f32_32x32x16_bf16 v[32:47], v[112:115], v[164:167], v[32:47]
    v_mfma_f32_32x32x16_bf16 v[48:63], v[116:119], v[160:163], v[48:63]
    v_mfma_f32_32x32x16_bf16 v[64:79], v[116:119], v[164:167], v[64:79]
    v_mfma_f32_32x32x16_bf16 v[16:31], v[120:123], v[168:171], v[16:31]
    v_mfma_f32_32x32x16_bf16 v[32:47], v[120:123], v[172:175], v[32:47]
    v_mfma_f32_32x32x16_bf16 v[48:63], v[124:127], v[168:171], v[48:63]
    v_mfma_f32_32x32x16_bf16 v[64:79], v[124:127], v[172:175], v[64:79]
    s_nop 3
    s_waitcnt vmcnt(16)
    s_waitcnt lgkmcnt(0)
    v_mfma_f32_32x32x16_bf16 v[16:31], v[128:131], v[176:179], v[16:31]
    v_mfma_f32_32x32x16_bf16 v[32:47], v[128:131], v[180:183], v[32:47]
    v_mfma_f32_32x32x16_bf16 v[48:63], v[132:135], v[176:179], v[48:63]
    v_mfma_f32_32x32x16_bf16 v[64:79], v[132:135], v[180:183], v[64:79]
    v_mfma_f32_32x32x16_bf16 v[16:31], v[136:139], v[184:187], v[16:31]
    v_mfma_f32_32x32x16_bf16 v[32:47], v[136:139], v[188:191], v[32:47]
    v_mfma_f32_32x32x16_bf16 v[48:63], v[140:143], v[184:187], v[48:63]
    v_mfma_f32_32x32x16_bf16 v[64:79], v[140:143], v[188:191], v[64:79]
    s_nop 3
    s_waitcnt lgkmcnt(0)
    s_lshr_b32 s52, s6, 1
    s_lshl_b32 s52, s52, 6
    v_subrev_u32 v5, s50, v12
    v_xor_b32 v5, s52, v5
    s_add_u32 s52, s6, 0
    s_and_b32 s52, s52, 3
    s_mul_i32 s52, s52, 20480
    v_add_u32 v6, s52, v5
    s_add_u32 s52, s6, 1
    s_and_b32 s52, s52, 3
    s_mul_i32 s52, s52, 20480
    v_add_u32 v7, s52, v5
    s_add_u32 s52, s6, 2
    s_and_b32 s52, s52, 3
    s_mul_i32 s52, s52, 20480
    v_add_u32 v10, s52, v5
    s_add_u32 s52, s6, 3
    s_and_b32 s52, s52, 3
    s_mul_i32 s52, s52, 20480
    v_add_u32 v11, s52, v5
    v_add_u32 v9, s50, v2
    s_lshl_b32 s52, s6, 14
    s_add_u32 s52, s52, 81920
    v_add_u32 v9, s52, v2
    s_and_b32 s7, s6, 1
    s_lshl_b32 s52, s7, 7
    s_add_u32 s52, s52, 160768
    v_and_b32 v13, 31, v1
    v_lshlrev_b32 v13, 2, v13
    v_add_u32 v13, s52, v13
    v_mov_b32 v14, 162148
lw_18:
    ds_read_b32 v15, v14
    s_waitcnt lgkmcnt(0)
    v_readfirstlane_b32 s52, v15
    s_cmp_ge_u32 s52, 4
    s_cbranch_scc1 lw_18_d
    s_sleep 1
    s_add_u32 s58, s58, 1
    s_cmp_lt_u32 s58, 200000
    s_cbranch_scc1 lw_18
lw_18_d:
    ds_read_b32 v13, v13
    s_cmp_lg_u32 s6, 0
    s_cbranch_scc1 G_x1
    ds_write_b128 v9, v[32:35] offset:4096
    ds_write_b128 v9, v[36:39] offset:5120
    ds_write_b128 v9, v[40:43] offset:6144
    ds_write_b128 v9, v[44:47] offset:7168
    ds_write_b128 v9, v[48:51] offset:8192
    ds_write_b128 v9, v[52:55] offset:9216
    ds_write_b128 v9, v[56:59] offset:10240
    ds_write_b128 v9, v[60:63] offset:11264
    ds_write_b128 v9, v[64:67] offset:12288
    ds_write_b128 v9, v[68:71] offset:13312
    ds_write_b128 v9, v[72:75] offset:14336
    ds_write_b128 v9, v[76:79] offset:15360
    v_mov_b32 v14, 162076
    v_mov_b32 v15, 1
    s_mov_b64 exec, 1
    ds_add_u32 v14, v15
    s_mov_b64 exec, -1
    v_add_u32 v3, 81920, v2
    v_mov_b32 v14, 162076
lw_19:
    ds_read_b32 v15, v14
    s_waitcnt lgkmcnt(0)
    v_readfirstlane_b32 s52, v15
    s_cmp_ge_u32 s52, 4
    s_cbranch_scc1 lw_19_d
    s_sleep 1
    s_add_u32 s58, s58, 1
    s_cmp_lt_u32 s58, 200000
    s_cbranch_scc1 lw_19
lw_19_d:
    v_sub_f32 v13, 1.0, v13
    ds_read_b128 v[208:211], v3 offset:16384
    ds_read_b128 v[212:215], v3 offset:17408
    ds_read_b128 v[216:219], v3 offset:18432
    ds_read_b128 v[220:223], v3 offset:19456
    ds_read_b128 v[224:227], v3 offset:32768
    ds_read_b128 v[228:231], v3 offset:33792
    ds_read_b128 v[232:235], v3 offset:34816
    ds_read_b128 v[236:239], v3 offset:35840
    ds_read_b128 v[240:243], v3 offset:49152
    ds_read_b128 v[244:247], v3 offset:50176
    ds_read_b128 v[248:251], v3 offset:51200
    ds_read_b128 v[252:255], v3 offset:52224
    s_waitcnt lgkmcnt(4)
    v_add_f32 v16, v16, v208
    v_add_f32 v17, v17, v209
    v_add_f32 v18, v18, v210
    v_add_f32 v19, v19, v211
    v_add_f32 v20, v20, v212
    v_add_f32 v21, v21, v213
    v_add_f32 v22, v22, v214
    v_add_f32 v23, v23, v215
    v_add_f32 v24, v24, v216
    v_add_f32 v25, v25, v217
    v_add_f32 v26, v26, v218
    v_add_f32 v27, v27, v219
    v_add_f32 v28, v28, v220
    v_add_f32 v29, v29, v221
    v_add_f32 v30, v30, v222
    v_add_f32 v31, v31, v223
    s_waitcnt lgkmcnt(0)
    v_add_f32 v224, v224, v240
    v_add_f32 v225, v225, v241
    v_add_f32 v226, v226, v242
    v_add_f32 v227, v227, v243
    v_add_f32 v228, v228, v244
    v_add_f32 v229, v229, v245
    v_add_f32 v230, v230, v246
    v_add_f32 v231, v231, v247
    v_add_f32 v232, v232, v248
    v_add_f32 v233, v233, v249
    v_add_f32 v234, v234, v250
    v_add_f32 v235, v235, v251
    v_add_f32 v236, v236, v252
    v_add_f32 v237, v237, v253
    v_add_f32 v238, v238, v254
    v_add_f32 v239, v239, v255
    v_add_f32 v16, v16, v224
    v_add_f32 v17, v17, v225
    v_add_f32 v18, v18, v226
    v_add_f32 v19, v19, v227
    v_add_f32 v20, v20, v228
    v_add_f32 v21, v21, v229
    v_add_f32 v22, v22, v230
    v_add_f32 v23, v23, v231
    v_add_f32 v24, v24, v232
    v_add_f32 v25, v25, v233
    v_add_f32 v26, v26, v234
    v_add_f32 v27, v27, v235
    v_add_f32 v28, v28, v236
    v_add_f32 v29, v29, v237
    v_add_f32 v30, v30, v238
    v_add_f32 v31, v31, v239
    v_mul_f32 v16, v13, v16
    v_mul_f32 v17, v13, v17
    v_mul_f32 v18, v13, v18
    v_mul_f32 v19, v13, v19
    v_mul_f32 v20, v13, v20
    v_mul_f32 v21, v13, v21
    v_mul_f32 v22, v13, v22
    v_mul_f32 v23, v13, v23
    v_mul_f32 v24, v13, v24
    v_mul_f32 v25, v13, v25
    v_mul_f32 v26, v13, v26
    v_mul_f32 v27, v13, v27
    v_mul_f32 v28, v13, v28
    v_mul_f32 v29, v13, v29
    v_mul_f32 v30, v13, v30
    v_mul_f32 v31, v13, v31
    s_branch G_xd
G_x1:
    s_cmp_lg_u32 s6, 1
    s_cbranch_scc1 G_x2
    ds_write_b128 v9, v[16:19] offset:0
    ds_write_b128 v9, v[20:23] offset:1024
    ds_write_b128 v9, v[24:27] offset:2048
    ds_write_b128 v9, v[28:31] offset:3072
    ds_write_b128 v9, v[48:51] offset:8192
    ds_write_b128 v9, v[52:55] offset:9216
    ds_write_b128 v9, v[56:59] offset:10240
    ds_write_b128 v9, v[60:63] offset:11264
    ds_write_b128 v9, v[64:67] offset:12288
    ds_write_b128 v9, v[68:71] offset:13312
    ds_write_b128 v9, v[72:75] offset:14336
    ds_write_b128 v9, v[76:79] offset:15360
    v_mov_b32 v14, 162076
    v_mov_b32 v15, 1
    s_mov_b64 exec, 1
    ds_add_u32 v14, v15
    s_mov_b64 exec, -1
    v_add_u32 v3, 86016, v2
    v_mov_b32 v14, 162076
lw_20:
    ds_read_b32 v15, v14
    s_waitcnt lgkmcnt(0)
    v_readfirstlane_b32 s52, v15
    s_cmp_ge_u32 s52, 4
    s_cbranch_scc1 lw_20_d
    s_sleep 1
    s_add_u32 s58, s58, 1
    s_cmp_lt_u32 s58, 200000
    s_cbranch_scc1 lw_20
lw_20_d:
    v_sub_f32 v13, 1.0, v13
    ds_read_b128 v[208:211], v3 offset:0
    ds_read_b128 v[212:215], v3 offset:1024
    ds_read_b128 v[216:219], v3 offset:2048
    ds_read_b128 v[220:223], v3 offset:3072
    ds_read_b128 v[224:227], v3 offset:32768
    ds_read_b128 v[228:231], v3 offset:33792
    ds_read_b128 v[232:235], v3 offset:34816
    ds_read_b128 v[236:239], v3 offset:35840
    ds_read_b128 v[240:243], v3 offset:49152
    ds_read_b128 v[244:247], v3 offset:50176
    ds_read_b128 v[248:251], v3 offset:51200
    ds_read_b128 v[252:255], v3 offset:52224
    s_waitcnt lgkmcnt(4)
    v_add_f32 v32, v32, v208
    v_add_f32 v33, v33, v209
    v_add_f32 v34, v34, v210
    v_add_f32 v35, v35, v211
    v_add_f32 v36, v36, v212
    v_add_f32 v37, v37, v213
    v_add_f32 v38, v38, v214
    v_add_f32 v39, v39, v215
    v_add_f32 v40, v40, v216
    v_add_f32 v41, v41, v217
    v_add_f32 v42, v42, v218
    v_add_f32 v43, v43, v219
    v_add_f32 v44, v44, v220
    v_add_f32 v45, v45, v221
    v_add_f32 v46, v46, v222
    v_add_f32 v47, v47, v223
    s_waitcnt lgkmcnt(0)
    v_add_f32 v224, v224, v240
    v_add_f32 v225, v225, v241
    v_add_f32 v226, v226, v242
    v_add_f32 v227, v227, v243
    v_add_f32 v228, v228, v244
    v_add_f32 v229, v229, v245
    v_add_f32 v230, v230, v246
    v_add_f32 v231, v231, v247
    v_add_f32 v232, v232, v248
    v_add_f32 v233, v233, v249
    v_add_f32 v234, v234, v250
    v_add_f32 v235, v235, v251
    v_add_f32 v236, v236, v252
    v_add_f32 v237, v237, v253
    v_add_f32 v238, v238, v254
    v_add_f32 v239, v239, v255
    v_add_f32 v32, v32, v224
    v_add_f32 v33, v33, v225
    v_add_f32 v34, v34, v226
    v_add_f32 v35, v35, v227
    v_add_f32 v36, v36, v228
    v_add_f32 v37, v37, v229
    v_add_f32 v38, v38, v230
    v_add_f32 v39, v39, v231
    v_add_f32 v40, v40, v232
    v_add_f32 v41, v41, v233
    v_add_f32 v42, v42, v234
    v_add_f32 v43, v43, v235
    v_add_f32 v44, v44, v236
    v_add_f32 v45, v45, v237
    v_add_f32 v46, v46, v238
    v_add_f32 v47, v47, v239
    v_mul_f32 v16, v13, v32
    v_mul_f32 v17, v13, v33
    v_mul_f32 v18, v13, v34
    v_mul_f32 v19, v13, v35
    v_mul_f32 v20, v13, v36
    v_mul_f32 v21, v13, v37
    v_mul_f32 v22, v13, v38
    v_mul_f32 v23, v13, v39
    v_mul_f32 v24, v13, v40
    v_mul_f32 v25, v13, v41
    v_mul_f32 v26, v13, v42
    v_mul_f32 v27, v13, v43
    v_mul_f32 v28, v13, v44
    v_mul_f32 v29, v13, v45
    v_mul_f32 v30, v13, v46
    v_mul_f32 v31, v13, v47
    s_branch G_xd
G_x2:
    s_cmp_lg_u32 s6, 2
    s_cbranch_scc1 G_x3
    ds_write_b128 v9, v[16:19] offset:0
    ds_write_b128 v9, v[20:23] offset:1024
    ds_write_b128 v9, v[24:27] offset:2048
    ds_write_b128 v9, v[28:31] offset:3072
    ds_write_b128 v9, v[32:35] offset:4096
    ds_write_b128 v9, v[36:39] offset:5120
    ds_write_b128 v9, v[40:43] offset:6144
    ds_write_b128 v9, v[44:47] offset:7168
    ds_write_b128 v9, v[64:67] offset:12288
    ds_write_b128 v9, v[68:71] offset:13312
    ds_write_b128 v9, v[72:75] offset:14336
    ds_write_b128 v9, v[76:79] offset:15360
    v_mov_b32 v14, 162076
    v_mov_b32 v15, 1
    s_mov_b64 exec, 1
    ds_add_u32 v14, v15
    s_mov_b64 exec, -1
    v_add_u32 v3, 90112, v2
    v_mov_b32 v14, 162076
lw_21:
    ds_read_b32 v15, v14
    s_waitcnt lgkmcnt(0)
    v_readfirstlane_b32 s52, v15
    s_cmp_ge_u32 s52, 4
    s_cbranch_scc1 lw_21_d
    s_sleep 1
    s_add_u32 s58, s58, 1
    s_cmp_lt_u32 s58, 200000
    s_cbranch_scc1 lw_21
lw_21_d:
    v_sub_f32 v13, 1.0, v13
    ds_read_b128 v[208:211], v3 offset:0
    ds_read_b128 v[212:215], v3 offset:1024
    ds_read_b128 v[216:219], v3 offset:2048
    ds_read_b128 v[220:223], v3 offset:3072
    ds_read_b128 v[224:227], v3 offset:16384
    ds_read_b128 v[228:231], v3 offset:17408
    ds_read_b128 v[232:235], v3 offset:18432
    ds_read_b128 v[236:239], v3 offset:19456
    ds_read_b128 v[240:243], v3 offset:49152
    ds_read_b128 v[244:247], v3 offset:50176
    ds_read_b128 v[248:251], v3 offset:51200
    ds_read_b128 v[252:255], v3 offset:52224
    s_waitcnt lgkmcnt(4)
    v_add_f32 v48, v48, v208
    v_add_f32 v49, v49, v209
    v_add_f32 v50, v50, v210
    v_add_f32 v51, v51, v211
    v_add_f32 v52, v52, v212
    v_add_f32 v53, v53, v213
    v_add_f32 v54, v54, v214
    v_add_f32 v55, v55, v215
    v_add_f32 v56, v56, v216
    v_add_f32 v57, v57, v217
    v_add_f32 v58, v58, v218
    v_add_f32 v59, v59, v219
    v_add_f32 v60, v60, v220
    v_add_f32 v61, v61, v221
    v_add_f32 v62, v62, v222
    v_add_f32 v63, v63, v223
    s_waitcnt lgkmcnt(0)
    v_add_f32 v224, v224, v240
    v_add_f32 v225, v225, v241
    v_add_f32 v226, v226, v242
    v_add_f32 v227, v227, v243
    v_add_f32 v228, v228, v244
    v_add_f32 v229, v229, v245
    v_add_f32 v230, v230, v246
    v_add_f32 v231, v231, v247
    v_add_f32 v232, v232, v248
    v_add_f32 v233, v233, v249
    v_add_f32 v234, v234, v250
    v_add_f32 v235, v235, v251
    v_add_f32 v236, v236, v252
    v_add_f32 v237, v237, v253
    v_add_f32 v238, v238, v254
    v_add_f32 v239, v239, v255
    v_add_f32 v48, v48, v224
    v_add_f32 v49, v49, v225
    v_add_f32 v50, v50, v226
    v_add_f32 v51, v51, v227
    v_add_f32 v52, v52, v228
    v_add_f32 v53, v53, v229
    v_add_f32 v54, v54, v230
    v_add_f32 v55, v55, v231
    v_add_f32 v56, v56, v232
    v_add_f32 v57, v57, v233
    v_add_f32 v58, v58, v234
    v_add_f32 v59, v59, v235
    v_add_f32 v60, v60, v236
    v_add_f32 v61, v61, v237
    v_add_f32 v62, v62, v238
    v_add_f32 v63, v63, v239
    v_mul_f32 v16, v13, v48
    v_mul_f32 v17, v13, v49
    v_mul_f32 v18, v13, v50
    v_mul_f32 v19, v13, v51
    v_mul_f32 v20, v13, v52
    v_mul_f32 v21, v13, v53
    v_mul_f32 v22, v13, v54
    v_mul_f32 v23, v13, v55
    v_mul_f32 v24, v13, v56
    v_mul_f32 v25, v13, v57
    v_mul_f32 v26, v13, v58
    v_mul_f32 v27, v13, v59
    v_mul_f32 v28, v13, v60
    v_mul_f32 v29, v13, v61
    v_mul_f32 v30, v13, v62
    v_mul_f32 v31, v13, v63
    s_branch G_xd
G_x3:
    ds_write_b128 v9, v[16:19] offset:0
    ds_write_b128 v9, v[20:23] offset:1024
    ds_write_b128 v9, v[24:27] offset:2048
    ds_write_b128 v9, v[28:31] offset:3072
    ds_write_b128 v9, v[32:35] offset:4096
    ds_write_b128 v9, v[36:39] offset:5120
    ds_write_b128 v9, v[40:43] offset:6144
    ds_write_b128 v9, v[44:47] offset:7168
    ds_write_b128 v9, v[48:51] offset:8192
    ds_write_b128 v9, v[52:55] offset:9216
    ds_write_b128 v9, v[56:59] offset:10240
    ds_write_b128 v9, v[60:63] offset:11264
    v_mov_b32 v14, 162076
    v_mov_b32 v15, 1
    s_mov_b64 exec, 1
    ds_add_u32 v14, v15
    s_mov_b64 exec, -1
    v_add_u32 v3, 94208, v2
    v_mov_b32 v14, 162076
lw_22:
    ds_read_b32 v15, v14
    s_waitcnt lgkmcnt(0)
    v_readfirstlane_b32 s52, v15
    s_cmp_ge_u32 s52, 4
    s_cbranch_scc1 lw_22_d
    s_sleep 1
    s_add_u32 s58, s58, 1
    s_cmp_lt_u32 s58, 200000
    s_cbranch_scc1 lw_22
lw_22_d:
    v_sub_f32 v13, 1.0, v13
    ds_read_b128 v[208:211], v3 offset:0
    ds_read_b128 v[212:215], v3 offset:1024
    ds_read_b128 v[216:219], v3 offset:2048
    ds_read_b128 v[220:223], v3 offset:3072
    ds_read_b128 v[224:227], v3 offset:16384
    ds_read_b128 v[228:231], v3 offset:17408
    ds_read_b128 v[232:235], v3 offset:18432
    ds_read_b128 v[236:239], v3 offset:19456
    ds_read_b128 v[240:243], v3 offset:32768
    ds_read_b128 v[244:247], v3 offset:33792
    ds_read_b128 v[248:251], v3 offset:34816
    ds_read_b128 v[252:255], v3 offset:35840
    s_waitcnt lgkmcnt(4)
    v_add_f32 v64, v64, v208
    v_add_f32 v65, v65, v209
    v_add_f32 v66, v66, v210
    v_add_f32 v67, v67, v211
    v_add_f32 v68, v68, v212
    v_add_f32 v69, v69, v213
    v_add_f32 v70, v70, v214
    v_add_f32 v71, v71, v215
    v_add_f32 v72, v72, v216
    v_add_f32 v73, v73, v217
    v_add_f32 v74, v74, v218
    v_add_f32 v75, v75, v219
    v_add_f32 v76, v76, v220
    v_add_f32 v77, v77, v221
    v_add_f32 v78, v78, v222
    v_add_f32 v79, v79, v223
    s_waitcnt lgkmcnt(0)
    v_add_f32 v224, v224, v240
    v_add_f32 v225, v225, v241
    v_add_f32 v226, v226, v242
    v_add_f32 v227, v227, v243
    v_add_f32 v228, v228, v244
    v_add_f32 v229, v229, v245
    v_add_f32 v230, v230, v246
    v_add_f32 v231, v231, v247
    v_add_f32 v232, v232, v248
    v_add_f32 v233, v233, v249
    v_add_f32 v234, v234, v250
    v_add_f32 v235, v235, v251
    v_add_f32 v236, v236, v252
    v_add_f32 v237, v237, v253
    v_add_f32 v238, v238, v254
    v_add_f32 v239, v239, v255
    v_add_f32 v64, v64, v224
    v_add_f32 v65, v65, v225
    v_add_f32 v66, v66, v226
    v_add_f32 v67, v67, v227
    v_add_f32 v68, v68, v228
    v_add_f32 v69, v69, v229
    v_add_f32 v70, v70, v230
    v_add_f32 v71, v71, v231
    v_add_f32 v72, v72, v232
    v_add_f32 v73, v73, v233
    v_add_f32 v74, v74, v234
    v_add_f32 v75, v75, v235
    v_add_f32 v76, v76, v236
    v_add_f32 v77, v77, v237
    v_add_f32 v78, v78, v238
    v_add_f32 v79, v79, v239
    v_mul_f32 v16, v13, v64
    v_mul_f32 v17, v13, v65
    v_mul_f32 v18, v13, v66
    v_mul_f32 v19, v13, v67
    v_mul_f32 v20, v13, v68
    v_mul_f32 v21, v13, v69
    v_mul_f32 v22, v13, v70
    v_mul_f32 v23, v13, v71
    v_mul_f32 v24, v13, v72
    v_mul_f32 v25, v13, v73
    v_mul_f32 v26, v13, v74
    v_mul_f32 v27, v13, v75
    v_mul_f32 v28, v13, v76
    v_mul_f32 v29, v13, v77
    v_mul_f32 v30, v13, v78
    v_mul_f32 v31, v13, v79
G_xd0:
G_xd:
    s_waitcnt vmcnt(0)
    v_mov_b32 v14, 162096
    v_mov_b32 v15, 1
    s_mov_b64 exec, 1
    ds_add_u32 v14, v15
    s_mov_b64 exec, -1
    s_lshl_b32 s54, s4, 16
    s_lshl_b32 s52, s6, 13
    s_add_u32 s54, s54, s52
    s_add_u32 s54, s54, 12582912
    s_lshl_b32 s52, s7, 15
    s_xor_b32 s55, s52, 32768
    s_add_u32 s55, s55, s54
    s_add_u32 s54, s54, s52
    s_lshl_b32 s56, s6, 1
    s_lshl_b32 s56, 0x300, s56
    v_and_b32 v8, 31, v1
    v_lshrrev_b32 v9, 5, v1
    s_and_b32 s52, s6, 1
    s_lshl_b32 s52, s52, 5
    s_lshl_b32 s53, s4, 6
    s_add_u32 s52, s52, s53
    v_add_u32 v8, s52, v8
    v_lshlrev_b32 v8, 10, v8
    v_lshl_add_u32 v8, v9, 4, v8
    s_lshl_b32 s57, s5, 7
    s_lshr_b32 s52, s6, 1
    s_lshl_b32 s52, s52, 6
    s_add_u32 s57, s57, s52
    v_mov_b32 v14, 162096
lw_23:
    ds_read_b32 v15, v14
    s_waitcnt lgkmcnt(0)
    v_readfirstlane_b32 s52, v15
    s_cmp_ge_u32 s52, 4
    s_cbranch_scc1 lw_23_d
    s_sleep 1
    s_add_u32 s58, s58, 1
    s_cmp_lt_u32 s58, 200000
    s_cbranch_scc1 lw_23
lw_23_d:
    s_barrier
    s_mov_b32 exec_lo, s56
    s_mov_b32 exec_hi, 0
    buffer_load_dword v3, v4, s[44:47], s61 offen sc1
    s_mov_b64 exec, -1
    ds_read_b64_tr_b16 v[80:81], v6 offset:16384
    ds_read_b64_tr_b16 v[82:83], v6 offset:17408
    ds_read_b64_tr_b16 v[84:85], v6 offset:18432
    ds_read_b64_tr_b16 v[86:87], v6 offset:19456
    ds_read_b64_tr_b16 v[88:89], v6 offset:0
    ds_read_b64_tr_b16 v[90:91], v6 offset:1024
    ds_read_b64_tr_b16 v[92:93], v6 offset:2048
    ds_read_b64_tr_b16 v[94:95], v6 offset:3072
    ds_read_b64_tr_b16 v[96:97], v6 offset:4096
    ds_read_b64_tr_b16 v[98:99], v6 offset:5120
    ds_read_b64_tr_b16 v[100:101], v6 offset:6144
    ds_read_b64_tr_b16 v[102:103], v6 offset:7168
    ds_read_b64_tr_b16 v[104:105], v6 offset:8192
    ds_read_b64_tr_b16 v[106:107], v6 offset:9216
    ds_read_b64_tr_b16 v[108:109], v6 offset:10240
    ds_read_b64_tr_b16 v[110:111], v6 offset:11264
    ds_read_b64_tr_b16 v[112:113], v7 offset:16384
    ds_read_b64_tr_b16 v[114:115], v7 offset:17408
    ds_read_b64_tr_b16 v[116:117], v7 offset:18432
    ds_read_b64_tr_b16 v[118:119], v7 offset:19456
    ds_read_b64_tr_b16 v[120:121], v7 offset:0
    ds_read_b64_tr_b16 v[122:123], v7 offset:1024
    ds_read_b64_tr_b16 v[124:125], v7 offset:2048
    ds_read_b64_tr_b16 v[126:127], v7 offset:3072
    ds_read_b64_tr_b16 v[128:129], v7 offset:4096
    ds_read_b64_tr_b16 v[130:131], v7 offset:5120
    ds_read_b64_tr_b16 v[132:133], v7 offset:6144
    ds_read_b64_tr_b16 v[134:135], v7 offset:7168
    ds_read_b64_tr_b16 v[136:137], v7 offset:8192
    ds_read_b64_tr_b16 v[138:139], v7 offset:9216
    ds_read_b64_tr_b16 v[140:141], v7 offset:10240
    ds_read_b64_tr_b16 v[142:143], v7 offset:11264
    ds_read_b64_tr_b16 v[144:145], v10 offset:16384
    ds_read_b64_tr_b16 v[146:147], v10 offset:17408
    ds_read_b64_tr_b16 v[148:149], v10 offset:18432
    ds_read_b64_tr_b16 v[150:151], v10 offset:19456
    ds_read_b64_tr_b16 v[152:153], v10 offset:0
    ds_read_b64_tr_b16 v[154:155], v10 offset:1024
    ds_read_b64_tr_b16 v[156:157], v10 offset:2048
    ds_read_b64_tr_b16 v[158:159], v10 offset:3072
    ds_read_b64_tr_b16 v[160:161], v10 offset:4096
    ds_read_b64_tr_b16 v[162:163], v10 offset:5120
    ds_read_b64_tr_b16 v[164:165], v10 offset:6144
    ds_read_b64_tr_b16 v[166:167], v10 offset:7168
    ds_read_b64_tr_b16 v[168:169], v10 offset:8192
    ds_read_b64_tr_b16 v[170:171], v10 offset:9216
    ds_read_b64_tr_b16 v[172:173], v10 offset:10240
    ds_read_b64_tr_b16 v[174:175], v10 offset:11264
    ds_read_b64_tr_b16 v[176:177], v11 offset:16384
    ds_read_b64_tr_b16 v[178:179], v11 offset:17408
    ds_read_b64_tr_b16 v[180:181], v11 offset:18432
    ds_read_b64_tr_b16 v[182:183], v11 offset:19456
    ds_read_b64_tr_b16 v[184:185], v11 offset:0
    ds_read_b64_tr_b16 v[186:187], v11 offset:1024
    ds_read_b64_tr_b16 v[188:189], v11 offset:2048
    ds_read_b64_tr_b16 v[190:191], v11 offset:3072
    ds_read_b64_tr_b16 v[192:193], v11 offset:4096
    ds_read_b64_tr_b16 v[194:195], v11 offset:5120
    ds_read_b64_tr_b16 v[196:197], v11 offset:6144
    ds_read_b64_tr_b16 v[198:199], v11 offset:7168
    ds_read_b64_tr_b16 v[200:201], v11 offset:8192
    ds_read_b64_tr_b16 v[202:203], v11 offset:9216
    ds_read_b64_tr_b16 v[204:205], v11 offset:10240
    ds_read_b64_tr_b16 v[206:207], v11 offset:11264
    v_mov_b32 v14, 162100
    v_mov_b32 v15, 1
    s_mov_b64 exec, 1
    ds_add_u32 v14, v15
    s_mov_b64 exec, -1
    s_lshl_b32 s52, s6, 13
    s_lshl_b32 s53, s7, 15
    s_add_u32 s52, s52, s53
    v_add_u32 v9, s52, v2
    v_xor_b32 v5, 32768, v9
    s_add_u32 s52, s6, 1
    s_and_b32 s52, s52, 3
    s_lshl_b32 s52, s52, 13
    s_add_u32 s52, s52, s53
    v_add_u32 v7, s52, v2
    s_add_u32 s52, s6, 2
    s_and_b32 s52, s52, 3
    s_lshl_b32 s52, s52, 13
    s_add_u32 s52, s52, s53
    v_add_u32 v10, s52, v2
    s_add_u32 s52, s6, 3
    s_and_b32 s52, s52, 3
    s_lshl_b32 s52, s52, 13
    s_add_u32 s52, s52, s53
    v_add_u32 v11, s52, v2
    s_waitcnt vmcnt(0)
    s_mov_b32 exec_lo, s56
    s_mov_b32 exec_hi, 0
    v_cmp_ne_u32 vcc, 0, v3
    s_mov_b64 exec, -1
    s_cmp_eq_u32 vcc_lo, s56
    s_cbranch_scc1 G_opx
    s_mov_b32 exec_lo, s56
    s_mov_b32 exec_hi, 0
G_op:
    buffer_load_dword v3, v4, s[44:47], s61 offen sc1
    s_waitcnt vmcnt(0)
    v_cmp_ne_u32 vcc, 0, v3
    s_cmp_eq_u32 vcc_lo, s56
    s_cbranch_scc1 G_op_d
    s_sleep 1
    s_add_u32 s58, s58, 1
    s_cmp_lt_u32 s58, 200000
    s_cbranch_scc1 G_op
G_op_d:
    s_mov_b64 exec, -1
G_opx:
    buffer_load_dwordx4 v[32:35], v2, s[44:47], s54 offen offset:0 sc1
    buffer_load_dwordx4 v[64:67], v2, s[44:47], s55 offen offset:0 sc1
    buffer_load_dwordx4 v[36:39], v2, s[44:47], s54 offen offset:1024 sc1
    buffer_load_dwordx4 v[68:71], v2, s[44:47], s55 offen offset:1024 sc1
    buffer_load_dwordx4 v[40:43], v2, s[44:47], s54 offen offset:2048 sc1
    buffer_load_dwordx4 v[72:75], v2, s[44:47], s55 offen offset:2048 sc1
    buffer_load_dwordx4 v[44:47], v2, s[44:47], s54 offen offset:3072 sc1
    buffer_load_dwordx4 v[76:79], v2, s[44:47], s55 offen offset:3072 sc1
    s_add_u32 s54, s54, 4096
    s_add_u32 s55, s55, 4096
    buffer_load_dwordx4 v[48:51], v2, s[44:47], s54 offen offset:0 sc1
    buffer_load_dwordx4 v[208:211], v2, s[44:47], s55 offen offset:0 sc1
    buffer_load_dwordx4 v[52:55], v2, s[44:47], s54 offen offset:1024 sc1
    buffer_load_dwordx4 v[212:215], v2, s[44:47], s55 offen offset:1024 sc1
    buffer_load_dwordx4 v[56:59], v2, s[44:47], s54 offen offset:2048 sc1
    buffer_load_dwordx4 v[216:219], v2, s[44:47], s55 offen offset:2048 sc1
    buffer_load_dwordx4 v[60:63], v2, s[44:47], s54 offen offset:3072 sc1
    buffer_load_dwordx4 v[220:223], v2, s[44:47], s55 offen offset:3072 sc1
    v_mov_b32 v14, 162100
lw_24:
    ds_read_b32 v15, v14
    s_waitcnt lgkmcnt(0)
    v_readfirstlane_b32 s52, v15
    s_cmp_ge_u32 s52, 4
    s_cbranch_scc1 lw_24_d
    s_sleep 1
    s_add_u32 s58, s58, 1
    s_cmp_lt_u32 s58, 200000
    s_cbranch_scc1 lw_24
lw_24_d:
    s_waitcnt vmcnt(15)
    ds_write_b128 v9, v[32:35] offset:0
    v_mfma_f32_32x32x16_bf16 v[16:31], v[80:83], v[32:35], v[16:31]
    s_waitcnt vmcnt(14)
    ds_write_b128 v5, v[64:67] offset:0
    s_waitcnt vmcnt(13)
    ds_write_b128 v9, v[36:39] offset:1024
    v_mfma_f32_32x32x16_bf16 v[16:31], v[84:87], v[36:39], v[16:31]
    s_waitcnt vmcnt(12)
    ds_write_b128 v5, v[68:71] offset:1024
    s_waitcnt vmcnt(11)
    ds_write_b128 v9, v[40:43] offset:2048
    v_mfma_f32_32x32x16_bf16 v[16:31], v[88:91], v[40:43], v[16:31]
    s_waitcnt vmcnt(10)
    ds_write_b128 v5, v[72:75] offset:2048
    s_waitcnt vmcnt(9)
    ds_write_b128 v9, v[44:47] offset:3072
    v_mfma_f32_32x32x16_bf16 v[16:31], v[92:95], v[44:47], v[16:31]
    s_waitcnt vmcnt(8)
    ds_write_b128 v5, v[76:79] offset:3072
    s_waitcnt vmcnt(7)
    ds_write_b128 v9, v[48:51] offset:4096
    v_mfma_f32_32x32x16_bf16 v[16:31], v[96:99], v[48:51], v[16:31]
    s_waitcnt vmcnt(6)
    ds_write_b128 v5, v[208:211] offset:4096
    s_waitcnt vmcnt(5)
    ds_write_b128 v9, v[52:55] offset:5120
    v_mfma_f32_32x32x16_bf16 v[16:31], v[100:103], v[52:55], v[16:31]
    s_waitcnt vmcnt(4)
    ds_write_b128 v5, v[212:215] offset:5120
    s_waitcnt vmcnt(3)
    ds_write_b128 v9, v[56:59] offset:6144
    v_mfma_f32_32x32x16_bf16 v[16:31], v[104:107], v[56:59], v[16:31]
    s_waitcnt vmcnt(2)
    ds_write_b128 v5, v[216:219] offset:6144
    s_waitcnt vmcnt(1)
    ds_write_b128 v9, v[60:63] offset:7168
    v_mfma_f32_32x32x16_bf16 v[16:31], v[108:111], v[60:63], v[16:31]
    s_waitcnt vmcnt(0)
    ds_write_b128 v5, v[220:223] offset:7168
    v_mov_b32 v14, 162108
    v_mov_b32 v15, 1
    s_mov_b64 exec, 1
    ds_add_u32 v14, v15
    s_mov_b64 exec, -1
    v_mov_b32 v14, 162108
lw_25:
    ds_read_b32 v15, v14
    s_waitcnt lgkmcnt(0)
    v_readfirstlane_b32 s52, v15
    s_cmp_ge_u32 s52, 4
    s_cbranch_scc1 lw_25_d
    s_sleep 1
    s_add_u32 s58, s58, 1
    s_cmp_lt_u32 s58, 200000
    s_cbranch_scc1 lw_25
lw_25_d:
    ds_read_b128 v[224:227], v7 offset:0
    ds_read_b128 v[228:231], v7 offset:1024
    ds_read_b128 v[232:235], v7 offset:2048
    ds_read_b128 v[236:239], v7 offset:3072
    ds_read_b128 v[240:243], v7 offset:4096
    ds_read_b128 v[244:247], v7 offset:5120
    ds_read_b128 v[248:251], v7 offset:6144
    ds_read_b128 v[252:255], v7 offset:7168
    s_waitcnt lgkmcnt(7)
    v_mfma_f32_32x32x16_bf16 v[16:31], v[112:115], v[224:227], v[16:31]
    s_nop 1
    ds_read_b128 v[224:227], v10 offset:0
    s_waitcnt lgkmcnt(7)
    v_mfma_f32_32x32x16_bf16 v[16:31], v[116:119], v[228:231], v[16:31]
    s_nop 1
    ds_read_b128 v[228:231], v10 offset:1024
    s_waitcnt lgkmcnt(7)
    v_mfma_f32_32x32x16_bf16 v[16:31], v[120:123], v[232:235], v[16:31]
    s_nop 1
    ds_read_b128 v[232:235], v10 offset:2048
    s_waitcnt lgkmcnt(7)
    v_mfma_f32_32x32x16_bf16 v[16:31], v[124:127], v[236:239], v[16:31]
    s_nop 1
    ds_read_b128 v[236:239], v10 offset:3072
    s_waitcnt lgkmcnt(7)
    v_mfma_f32_32x32x16_bf16 v[16:31], v[128:131], v[240:243], v[16:31]
    s_nop 1
    ds_read_b128 v[240:243], v10 offset:4096
    s_waitcnt lgkmcnt(7)
    v_mfma_f32_32x32x16_bf16 v[16:31], v[132:135], v[244:247], v[16:31]
    s_nop 1
    ds_read_b128 v[244:247], v10 offset:5120
    s_waitcnt lgkmcnt(7)
    v_mfma_f32_32x32x16_bf16 v[16:31], v[136:139], v[248:251], v[16:31]
    s_nop 1
    ds_read_b128 v[248:251], v10 offset:6144
    s_waitcnt lgkmcnt(7)
    v_mfma_f32_32x32x16_bf16 v[16:31], v[140:143], v[252:255], v[16:31]
    s_nop 1
    ds_read_b128 v[252:255], v10 offset:7168
    s_waitcnt lgkmcnt(7)
    v_mfma_f32_32x32x16_bf16 v[16:31], v[144:147], v[224:227], v[16:31]
    s_nop 1
    ds_read_b128 v[224:227], v11 offset:0
    s_waitcnt lgkmcnt(7)
    v_mfma_f32_32x32x16_bf16 v[16:31], v[148:151], v[228:231], v[16:31]
    s_nop 1
    ds_read_b128 v[228:231], v11 offset:1024
    s_waitcnt lgkmcnt(7)
    v_mfma_f32_32x32x16_bf16 v[16:31], v[152:155], v[232:235], v[16:31]
    s_nop 1
    ds_read_b128 v[232:235], v11 offset:2048
    s_waitcnt lgkmcnt(7)
    v_mfma_f32_32x32x16_bf16 v[16:31], v[156:159], v[236:239], v[16:31]
    s_nop 1
    ds_read_b128 v[236:239], v11 offset:3072
    s_waitcnt lgkmcnt(7)
    v_mfma_f32_32x32x16_bf16 v[16:31], v[160:163], v[240:243], v[16:31]
    s_nop 1
    ds_read_b128 v[240:243], v11 offset:4096
    s_waitcnt lgkmcnt(7)
    v_mfma_f32_32x32x16_bf16 v[16:31], v[164:167], v[244:247], v[16:31]
    s_nop 1
    ds_read_b128 v[244:247], v11 offset:5120
    s_waitcnt lgkmcnt(7)
    v_mfma_f32_32x32x16_bf16 v[16:31], v[168:171], v[248:251], v[16:31]
    s_nop 1
    ds_read_b128 v[248:251], v11 offset:6144
    s_waitcnt lgkmcnt(7)
    v_mfma_f32_32x32x16_bf16 v[16:31], v[172:175], v[252:255], v[16:31]
    s_nop 1
    ds_read_b128 v[252:255], v11 offset:7168
    s_waitcnt lgkmcnt(7)
    v_mfma_f32_32x32x16_bf16 v[16:31], v[176:179], v[224:227], v[16:31]
    s_waitcnt lgkmcnt(6)
    v_mfma_f32_32x32x16_bf16 v[16:31], v[180:183], v[228:231], v[16:31]
    s_waitcnt lgkmcnt(5)
    v_mfma_f32_32x32x16_bf16 v[16:31], v[184:187], v[232:235], v[16:31]
    s_waitcnt lgkmcnt(4)
    v_mfma_f32_32x32x16_bf16 v[16:31], v[188:191], v[236:239], v[16:31]
    s_waitcnt lgkmcnt(3)
    v_mfma_f32_32x32x16_bf16 v[16:31], v[192:195], v[240:243], v[16:31]
    s_waitcnt lgkmcnt(2)
    v_mfma_f32_32x32x16_bf16 v[16:31], v[196:199], v[244:247], v[16:31]
    s_waitcnt lgkmcnt(1)
    v_mfma_f32_32x32x16_bf16 v[16:31], v[200:203], v[248:251], v[16:31]
    s_waitcnt lgkmcnt(0)
    v_mfma_f32_32x32x16_bf16 v[16:31], v[204:207], v[252:255], v[16:31]
    s_nop 15
    s_nop 3
    v_cvt_pk_bf16_f32 v128, v16, v17
    v_cvt_pk_bf16_f32 v129, v18, v19
    v_cvt_pk_bf16_f32 v130, v20, v21
    v_cvt_pk_bf16_f32 v131, v22, v23
    v_cvt_pk_bf16_f32 v132, v24, v25
    v_cvt_pk_bf16_f32 v133, v26, v27
    v_cvt_pk_bf16_f32 v134, v28, v29
    v_cvt_pk_bf16_f32 v135, v30, v31
    s_nop 1
    v_permlane32_swap_b32 v128, v130
    v_permlane32_swap_b32 v129, v131
    v_permlane32_swap_b32 v132, v134
    v_permlane32_swap_b32 v133, v135
    s_nop 1
    buffer_store_dwordx4 v[128:131], v8, s[32:35], s57 offen
    buffer_store_dwordx4 v[132:135], v8, s[32:35], s57 offen offset:32
F_end:
    s_endpgm
.section .rodata,"a"
.p2align 6
.amdhsa_kernel gated_mix__grouped_kv_mqa__dense_activation_relu__prompt_kernel
  .amdhsa_next_free_vgpr 256
  .amdhsa_next_free_sgpr 102
  .amdhsa_accum_offset 256
  .amdhsa_group_segment_fixed_size 0
  .amdhsa_kernarg_size 96
  .amdhsa_user_sgpr_count 2
  .amdhsa_user_sgpr_kernarg_segment_ptr 1
  .amdhsa_system_sgpr_workgroup_id_x 1
.end_amdhsa_kernel
```
